```python
import torch

def _softmax(x, axis=-1):
    return torch.softmax(x, dim=axis)
def _gelu(x):
    return torch.nn.functional.gelu(x, approximate="tanh")
def _silu(x):
    return torch.nn.functional.silu(x)
def _sigmoid(x):
    return torch.sigmoid(x)
def _layernorm(x, axis=-1, eps=1e-5):
    m = x.mean(dim=axis, keepdim=True)
    v = x.var(dim=axis, keepdim=True, unbiased=False)
    return (x - m) / torch.sqrt(v + eps)
def _scatter_add(tgt, idx, src, axis=0):
    return tgt.clone().index_add_(axis, idx, src)
def _segment_sum(src, seg, n):
    out = torch.zeros((n,) + src.shape[1:], dtype=src.dtype)
    return out.index_add_(0, seg, src)
def _pad(x, pw):
    flat = tuple(v for pair in reversed(pw) for v in pair)
    return torch.nn.functional.pad(x, flat)

kernel_name = 'concat_heads__spectral_fnet__grouped_kv_mqa__prompt'

def setup_inputs():

    _w = (lambda a: (lambda t: t.to(torch.bfloat16) if t.is_floating_point() else t)(torch.as_tensor(a)))
    def _A_setup():
        B, S, D = 1, 2048, 1024
        ns = torch.arange(S)[:, None] * torch.arange(S)[None, :]
        nd = torch.arange(D)[:, None] * torch.arange(D)[None, :]
        Ws_re = torch.cos(-2.0 * torch.pi * ns / S).to(float)
        Ws_im = torch.sin(-2.0 * torch.pi * ns / S).to(float)
        Wd_re = torch.cos(-2.0 * torch.pi * nd / D).to(float)
        Wd_im = torch.sin(-2.0 * torch.pi * nd / D).to(float)
        return {
            "x": _w((lambda *s: torch.randn(*s, dtype=torch.bfloat16) * 0.05)(B, S, D)),
            "dft_seq_re": _w(Ws_re),
            "dft_seq_im": _w(Ws_im),
            "dft_hid_re": _w(Wd_re),
            "dft_hid_im": _w(Wd_im),
        }
    _A_in = _A_setup()

    def _B_setup():
        B, S, D, H = 1, 2048, 1024, 32
        Dh = D // H
        return {
            "x": _w((lambda *s: torch.randn(*s, dtype=torch.bfloat16) * 0.05)(B, S, D)),
            "wq": _w((lambda *s: torch.randn(*s, dtype=torch.bfloat16) * 3.2)(D, H * Dh)),
            "wk": _w((lambda *s: torch.randn(*s, dtype=torch.bfloat16) * 3.2)(D, Dh)),
            "wv": _w((lambda *s: torch.randn(*s, dtype=torch.bfloat16) * 0.4)(D, Dh)),
            "wo": _w((lambda *s: torch.randn(*s, dtype=torch.bfloat16) * 0.4)(H * Dh, D)),
        }
    _B_in = _B_setup()

    return {
        "A_x": _A_in["x"],
        "A_dft_seq_re": _A_in["dft_seq_re"],
        "A_dft_seq_im": _A_in["dft_seq_im"],
        "A_dft_hid_re": _A_in["dft_hid_re"],
        "A_dft_hid_im": _A_in["dft_hid_im"],
        "B_x": _B_in["x"],
        "B_wq": _B_in["wq"],
        "B_wk": _B_in["wk"],
        "B_wv": _B_in["wv"],
        "B_wo": _B_in["wo"],
    }

def reference(A_x, A_dft_seq_re, A_dft_seq_im, A_dft_hid_re, A_dft_hid_im, B_x, B_wq, B_wk, B_wv, B_wo):
    def _A_ref(x, dft_seq_re, dft_seq_im, dft_hid_re, dft_hid_im):
        a = torch.einsum("bsd,ed->bse", x, dft_hid_re)
        b = torch.einsum("bsd,ed->bse", x, dft_hid_im)
        y = torch.einsum("ts,bse->bte", dft_seq_re, a) - torch.einsum("ts,bse->bte", dft_seq_im, b)
        return y

    def _B_ref(x, wq, wk, wv, wo):
        B, S, D = x.shape
        H = 32
        Dh = D // H
        q = (lambda x, *d: x.permute(*d))((x @ wq).reshape(B, S, H, Dh), 0, 2, 1, 3)
        k = x @ wk
        v = x @ wv
        scores = torch.einsum("bhqd,bkd->bhqk", q, k) * (Dh ** -0.5)
        p = _softmax(scores, axis=-1)
        o = torch.einsum("bhqk,bkd->bhqd", p, v)
        return (lambda x, *d: x.permute(*d))(o, 0, 2, 1, 3).reshape(B, S, H * Dh) @ wo

    a = _A_ref(A_x, A_dft_seq_re, A_dft_seq_im, A_dft_hid_re, A_dft_hid_im)
    b = _B_ref(B_x, B_wq, B_wk, B_wv, B_wo)
    return torch.concatenate([a, b], axis=-1)
```

```asm
; @launch grid=(256,1,1) block=(576,1,1) lds=163840
.amdgcn_target "amdgcn-amd-amdhsa--gfx950"
.text
.globl concat_heads__spectral_fnet__grouped_kv_mqa__prompt_kernel
.p2align 8
.type concat_heads__spectral_fnet__grouped_kv_mqa__prompt_kernel,@function
concat_heads__spectral_fnet__grouped_kv_mqa__prompt_kernel:
L_first:
    s_cmp_ge_u32 s2, 256
    s_cbranch_scc1 L_end
    s_load_dwordx16 s[12:27], s[0:1], 0
    s_load_dwordx8 s[28:35], s[0:1], 64
    s_load_dwordx2 s[36:37], s[0:1], 96
    v_lshrrev_b32 v1, 6, v0
    v_and_b32 v0, 63, v0
    s_and_b32 s6, s2, 7
    v_readfirstlane_b32 s3, v1
    s_lshr_b32 s7, s2, 3
    s_lshl_b32 s4, s6, 2
    s_and_b32 s8, s7, 3
    s_add_u32 s4, s4, s8
    s_lshr_b32 s5, s7, 2
    v_lshlrev_b32 v1, 4, v0
    v_lshrrev_b32 v4, 5, v0
    s_cmp_eq_u32 s3, 8
    s_cbranch_scc1 L_helper
    s_setprio 1
    s_lshl_b32 s74, s3, 10
    s_mov_b32 s84, 0x76453201
    s_mov_b32 s85, 0x67542310
    s_xor_b32 s82, s5, s6
    s_mul_i32 s82, s82, 0x11111111
    s_bitcmp1_b32 s7, 0
    s_cselect_b32 s8, 0x75643120, s84
    s_cselect_b32 s9, 0x76534210, s85
    s_bitcmp1_b32 s7, 1
    s_cselect_b32 s8, s9, s8
    s_xor_b32 s82, s82, s8
    s_and_b32 s77, s7, 3
    s_lshl_b32 s77, s77, 3
    s_lshl_b32 s99, s77, 11
    s_add_u32 s99, s99, s74
    v_lshrrev_b32 v5, 3, v0
    s_lshl_b32 s8, s3, 3
    v_add_u32 v5, s8, v5
    v_lshrrev_b32 v2, 1, v5
    v_xor_b32 v2, v2, v0
    v_and_b32 v2, 7, v2
    v_lshlrev_b32 v2, 4, v2
    s_lshl_b32 s9, s4, 6
    v_add_u32 v5, s9, v5
    v_lshl_add_u32 v5, v5, 11, v2
    s_waitcnt lgkmcnt(0)
    s_mov_b32 s40, s22
    s_mov_b32 s41, s23
    s_mov_b32 s42, 4194304
    s_mov_b32 s43, 0x20000
    s_cmp_ge_u32 s5, 4
    s_cselect_b32 s48, s28, s26
    s_cselect_b32 s49, s29, s27
    s_mov_b32 s50, 65536
    s_mov_b32 s51, 0x20000
    s_xor_b32 s76, s77, 0x30000
    s_xor_b32 s98, s99, 0
    s_bfe_u32 s76, s82, s76
    s_add_u32 m0, s98, 98304
    s_lshl_b32 s76, s76, 13
    s_add_u32 s76, s76, s74
    buffer_load_dwordx4 v1, s[48:51], s76 offen  lds
    s_xor_b32 s76, s77, 0x30004
    s_xor_b32 s98, s99, 8192
    s_bfe_u32 s76, s82, s76
    s_add_u32 m0, s98, 98304
    s_lshl_b32 s76, s76, 13
    s_add_u32 s76, s76, s74
    buffer_load_dwordx4 v1, s[48:51], s76 offen  lds
    s_bfe_u32 s81, s82, 0x30000
    s_add_u32 m0, s74, 49152
    s_lshl_b32 s81, s81, 8
    buffer_load_dwordx4 v5, s[40:43], s81 offen  lds
    s_add_u32 m0, s74, 57344
    s_add_u32 s81, s81, 128
    buffer_load_dwordx4 v5, s[40:43], s81 offen  lds
    s_xor_b32 s76, s77, 0x30008
    s_xor_b32 s98, s99, 16384
    s_bfe_u32 s76, s82, s76
    s_add_u32 m0, s98, 98304
    s_lshl_b32 s76, s76, 13
    s_add_u32 s76, s76, s74
    buffer_load_dwordx4 v1, s[48:51], s76 offen  lds
    s_mov_b32 s44, s24
    s_mov_b32 s45, s25
    s_mov_b32 s46, 2097152
    s_mov_b32 s47, 0x20000
    v_bfe_u32 v8, v0, 2, 2
    v_and_b32 v2, 31, v0
    v_bfe_u32 v3, v0, 1, 3
    v_xor_b32 v3, v3, v4
    v_lshlrev_b32 v3, 4, v3
    v_lshl_add_u32 v21, v2, 7, v3
    v_lshrrev_b32 v29, 4, v0
    s_and_b32 s8, s3, 1
    s_lshl_b32 s9, s8, 2
    v_add_u32 v28, s9, v29
    v_bfe_u32 v3, v0, 1, 3
    v_xor_b32 v28, v28, v3
    v_lshlrev_b32 v28, 4, v28
    v_and_b32 v3, 15, v0
    v_lshl_add_u32 v28, v3, 7, v28
    s_and_b32 s9, s5, 1
    s_lshl_b32 s9, s9, 12
    v_add_u32 v28, s9, v28
    s_lshr_b32 s83, s3, 1
    s_add_u32 s9, s83, 6
    s_and_b32 s9, s9, 7
    s_lshl_b32 s9, s9, 13
    v_add_u32 v31, s9, v28
    s_lshl_b32 s9, s83, 13
    v_add_u32 v28, s9, v28
    v_lshlrev_b32 v10, 3, v4
    v_add_u32 v10, v10, v8
    v_lshl_add_u32 v29, v29, 3, v8
    v_lshlrev_b32 v29, 6, v29
    v_and_b32 v3, 3, v0
    v_lshl_add_u32 v29, v3, 3, v29
    s_and_b32 s9, s5, 2
    s_lshl_b32 s9, s9, 4
    s_lshl_b32 s8, s8, 11
    s_add_u32 s9, s9, s8
    s_lshl_b32 s8, s83, 12
    s_add_u32 s9, s9, s8
    s_add_u32 s9, s9, 98304
    v_add_u32 v29, s9, v29
    s_and_b32 s72, s3, 3
    s_lshr_b32 s73, s3, 2
    s_lshl_b32 s75, s3, 12
    s_add_u32 s75, s75, 131072
    v_lshrrev_b32 v6, 2, v0
    s_lshl_b32 s9, s73, 5
    v_add_u32 v6, s9, v6
    v_and_b32 v3, 3, v0
    v_lshlrev_b32 v3, 4, v3
    v_lshl_add_u32 v6, v6, 11, v3
    s_lshl_b32 s9, s5, 2
    s_add_u32 s9, s9, s72
    s_lshl_b32 s9, s9, 6
    v_add_u32 v6, s9, v6
    v_bfe_u32 v2, v0, 4, 1
    v_lshlrev_b32 v2, 2, v2
    v_and_b32 v3, 3, v0
    v_or_b32 v2, v2, v3
    v_and_b32 v3, 1, v2
    v_lshlrev_b32 v3, 1, v3
    v_bfe_u32 v9, v2, 1, 1
    v_or_b32 v3, v3, v9
    v_and_b32 v9, 4, v2
    v_or_b32 v9, v9, v3
    v_lshlrev_b32 v9, 3, v9
    v_lshl_add_u32 v10, v10, 6, v9
    v_add_u32 v10, s75, v10
    s_lshl_b32 s9, s73, 6
    v_xor_b32 v26, s9, v21
    v_xor_b32 v27, 32, v26
    v_add_u32 v33, s75, v1
    v_xor_b32 v34, 0x4000, v33
    s_lshl_b32 s87, s3, 11
    s_add_u32 s87, s87, 49152
    s_sub_u32 s9, s87, s75
    v_add_u32 v35, s9, v10
    s_and_b32 s79, s7, 1
    s_lshr_b32 s38, s7, 1
    s_lshl_b32 s9, s6, 4
    s_add_u32 s39, s38, s9
    s_mov_b32 s10, s79
    s_sub_u32 s9, 256, s39
    s_cmp_eq_u32 s39, 0
    s_cselect_b32 s9, 128, s9
    s_cmp_eq_u32 s10, 0
    s_cselect_b32 s11, s39, s9
    s_mov_b32 s60, s36
    s_mov_b32 s61, s37
    s_mov_b32 s62, 16777216
    s_mov_b32 s63, 0x20000
    s_mov_b32 s64, s32
    s_mov_b32 s65, s33
    s_mov_b32 s66, 8388608
    s_mov_b32 s67, 0x20000
    s_mov_b32 s68, s30
    s_mov_b32 s69, s31
    s_mov_b32 s70, 2097152
    s_mov_b32 s71, 0x20000
    v_and_b32 v2, 15, v0
    s_cmp_ge_u32 s5, 4
    s_cselect_b32 s9, 4, 64
    v_mul_lo_u32 v30, v2, s9
    s_cselect_b32 s9, 512, 16
    v_lshrrev_b32 v3, 4, v0
    v_mul_lo_u32 v3, v3, s9
    s_mov_b32 s9, s87
    v_add3_u32 v30, v30, v3, s9
    v_lshrrev_b32 v2, 4, v0
    v_lshl_add_u32 v20, v2, 3, v8
    v_lshlrev_b32 v20, 7, v20
    v_and_b32 v3, 1, v2
    v_lshl_add_u32 v20, v3, 5, v20
    v_lshrrev_b32 v3, 1, v8
    s_and_b32 s9, s3, 1
    v_xor_b32 v3, s9, v3
    v_lshl_add_u32 v20, v3, 6, v20
    v_and_b32 v3, 3, v0
    v_lshl_add_u32 v20, v3, 3, v20
    v_add_u32 v20, 81920, v20
    v_xor_b32 v22, 32, v20
    s_lshl_b32 s9, s9, 2
    v_add_u32 v3, s9, v4
    v_xor_b32 v3, v3, v0
    v_and_b32 v3, 7, v3
    v_lshlrev_b32 v3, 4, v3
    v_and_b32 v2, 1, v2
    v_lshl_add_u32 v3, v2, 3, v3
    v_and_b32 v2, 15, v0
    v_lshl_add_u32 v11, v2, 7, v3
    s_lshr_b32 s9, s3, 1
    s_lshl_b32 s9, s9, 11
    s_add_u32 s8, s9, 81920
    v_add_u32 v11, s8, v11
    v_xor_b32 v25, 32, v11
    s_add_u32 s9, s9, 90112
    v_add_u32 v23, s9, v1
    s_xor_b32 s76, s77, 0x3000c
    s_xor_b32 s98, s99, 24576
    s_bfe_u32 s76, s82, s76
    s_add_u32 m0, s98, 98304
    s_lshl_b32 s76, s76, 13
    s_add_u32 s76, s76, s74
    buffer_load_dwordx4 v1, s[48:51], s76 offen  lds
    s_xor_b32 s76, s77, 0x30010
    s_xor_b32 s98, s99, 32768
    s_bfe_u32 s76, s82, s76
    s_add_u32 m0, s98, 98304
    s_lshl_b32 s76, s76, 13
    s_add_u32 s76, s76, s74
    buffer_load_dwordx4 v1, s[48:51], s76 offen  lds
    s_xor_b32 s76, s77, 0x30014
    s_xor_b32 s98, s99, 40960
    s_bfe_u32 s76, s82, s76
    s_add_u32 m0, s98, 98304
    s_lshl_b32 s76, s76, 13
    s_add_u32 s76, s76, s74
    buffer_load_dwordx4 v1, s[48:51], s76 offen  lds
    s_xor_b32 s76, s77, 0x30018
    s_xor_b32 s98, s99, 49152
    s_bfe_u32 s76, s82, s76
    s_add_u32 m0, s98, 98304
    s_lshl_b32 s76, s76, 13
    s_add_u32 s76, s76, s74
    buffer_load_dwordx4 v1, s[48:51], s76 offen  lds
    s_xor_b32 s76, s77, 0x3001c
    s_xor_b32 s98, s99, 57344
    s_bfe_u32 s76, s82, s76
    s_add_u32 m0, s98, 98304
    s_lshl_b32 s76, s76, 13
    s_add_u32 s76, s76, s74
    buffer_load_dwordx4 v1, s[48:51], s76 offen  lds
    s_bfe_u32 s81, s82, 0x30004
    s_add_u32 m0, s74, 0
    s_lshl_b32 s81, s81, 8
    buffer_load_dwordx4 v5, s[40:43], s81 offen  lds
    s_add_u32 m0, s74, 8192
    s_add_u32 s81, s81, 128
    buffer_load_dwordx4 v5, s[40:43], s81 offen  lds
    s_bfe_u32 s81, s82, 0x30008
    s_add_u32 m0, s74, 16384
    s_lshl_b32 s81, s81, 8
    buffer_load_dwordx4 v5, s[40:43], s81 offen  lds
    s_add_u32 m0, s74, 24576
    s_add_u32 s81, s81, 128
    buffer_load_dwordx4 v5, s[40:43], s81 offen  lds
    s_bfe_u32 s81, s82, 0x3000c
    s_add_u32 m0, s74, 32768
    s_lshl_b32 s81, s81, 8
    buffer_load_dwordx4 v5, s[40:43], s81 offen  lds
    s_add_u32 m0, s74, 40960
    s_add_u32 s81, s81, 128
    buffer_load_dwordx4 v5, s[40:43], s81 offen  lds
    s_waitcnt vmcnt(6)
    s_barrier
    s_setprio 0
    ds_read_b64_tr_b16 v[52:53], v29 offset:0
    ds_read_b64_tr_b16 v[54:55], v29 offset:256
    ds_read_b64_tr_b16 v[56:57], v29 offset:16384
    ds_read_b64_tr_b16 v[58:59], v29 offset:16640
    ds_read_b64_tr_b16 v[132:133], v29 offset:32768
    ds_read_b64_tr_b16 v[134:135], v29 offset:33024
    ds_read_b64_tr_b16 v[136:137], v29 offset:49152
    ds_read_b64_tr_b16 v[138:139], v29 offset:49408
    s_bfe_u32 s81, s82, 0x30010
    s_add_u32 m0, s74, 65536
    s_lshl_b32 s81, s81, 8
    buffer_load_dwordx4 v5, s[40:43], s81 offen  lds
    s_add_u32 m0, s74, 73728
    s_add_u32 s81, s81, 128
    buffer_load_dwordx4 v5, s[40:43], s81 offen  lds
    s_waitcnt lgkmcnt(0) vmcnt(2)
    s_barrier
    ds_read_b128 v[100:103], v31 offset:0
    ds_read_b128 v[104:107], v31 offset:2048
    ds_read_b128 v[108:111], v28 offset:16384
    ds_read_b128 v[112:115], v28 offset:18432
    s_bfe_u32 s83, s82, 0x30000
    s_add_u32 m0, s75, 0
    s_lshl_b32 s83, s83, 18
    buffer_load_dwordx4 v6, s[44:47], s83 offen lds
    s_add_u32 m0, s75, 1024
    s_add_u32 s83, s83, 32768
    buffer_load_dwordx4 v6, s[44:47], s83 offen lds
    s_waitcnt lgkmcnt(3)
    v_mfma_f32_16x16x32_bf16 v[68:71], v[52:55], v[100:103], 0
    s_add_u32 m0, s75, 2048
    s_add_u32 s83, s83, 98304
    buffer_load_dwordx4 v6, s[44:47], s83 offen lds
    s_add_u32 m0, s75, 3072
    s_add_u32 s83, s83, 32768
    buffer_load_dwordx4 v6, s[44:47], s83 offen lds
    s_waitcnt lgkmcnt(2)
    v_mfma_f32_16x16x32_bf16 v[72:75], v[52:55], v[104:107], 0
    s_bfe_u32 s81, s82, 0x30014
    s_add_u32 m0, s74, 81920
    s_lshl_b32 s81, s81, 8
    buffer_load_dwordx4 v5, s[40:43], s81 offen  lds
    s_add_u32 m0, s74, 90112
    s_add_u32 s81, s81, 128
    buffer_load_dwordx4 v5, s[40:43], s81 offen  lds
    s_waitcnt lgkmcnt(1)
    v_mfma_f32_16x16x32_bf16 v[68:71], v[56:59], v[108:111], v[68:71]
    s_bfe_u32 s81, s82, 0x30018
    s_add_u32 m0, s74, 98304
    s_lshl_b32 s81, s81, 8
    buffer_load_dwordx4 v5, s[40:43], s81 offen  lds
    s_add_u32 m0, s74, 106496
    s_add_u32 s81, s81, 128
    buffer_load_dwordx4 v5, s[40:43], s81 offen  lds
    s_waitcnt lgkmcnt(0)
    v_mfma_f32_16x16x32_bf16 v[72:75], v[56:59], v[112:115], v[72:75]
    s_bfe_u32 s81, s82, 0x3001c
    s_add_u32 m0, s74, 114688
    s_lshl_b32 s81, s81, 8
    buffer_load_dwordx4 v5, s[40:43], s81 offen  lds
    s_add_u32 m0, s74, 122880
    s_add_u32 s81, s81, 128
    buffer_load_dwordx4 v5, s[40:43], s81 offen  lds
    v_add_u32 v28, 0x10000, v28
    s_waitcnt vmcnt(9)
    s_cmp_eq_u32 s73, 0
    s_cbranch_scc1 L_qp
    s_setprio 1
L_qp:
    ds_read_b64_tr_b16 v[100:101], v10 offset:0
    ds_read_b64_tr_b16 v[102:103], v10 offset:256
    ds_read_b128 v[104:107], v26 offset:49152
    ds_read_b128 v[108:111], v26 offset:53248
    s_waitcnt vmcnt(8)
    ds_read_b64_tr_b16 v[116:117], v10 offset:1024
    ds_read_b64_tr_b16 v[118:119], v10 offset:1280
    ds_read_b128 v[120:123], v27 offset:49152
    ds_read_b128 v[124:127], v27 offset:53248
    s_waitcnt lgkmcnt(4)
    v_mfma_f32_32x32x16_bf16 v[52:67], v[100:103], v[104:107], 0
    s_bfe_u32 s83, s82, 0x30004
    s_add_u32 m0, s75, 0
    s_lshl_b32 s83, s83, 18
    buffer_load_dwordx4 v6, s[44:47], s83 offen lds
    v_mfma_f32_32x32x16_bf16 v[84:99], v[100:103], v[108:111], 0
    s_waitcnt vmcnt(8)
    ds_read_b64_tr_b16 v[100:101], v10 offset:2048
    ds_read_b64_tr_b16 v[102:103], v10 offset:2304
    ds_read_b128 v[104:107], v26 offset:57344
    ds_read_b128 v[108:111], v26 offset:61440
    s_waitcnt lgkmcnt(4)
    v_mfma_f32_32x32x16_bf16 v[52:67], v[116:119], v[120:123], v[52:67]
    s_add_u32 m0, s75, 1024
    s_add_u32 s83, s83, 32768
    buffer_load_dwordx4 v6, s[44:47], s83 offen lds
    v_mfma_f32_32x32x16_bf16 v[84:99], v[116:119], v[124:127], v[84:99]
    s_waitcnt vmcnt(8)
    ds_read_b64_tr_b16 v[116:117], v10 offset:3072
    ds_read_b64_tr_b16 v[118:119], v10 offset:3328
    ds_read_b128 v[120:123], v27 offset:57344
    ds_read_b128 v[124:127], v27 offset:61440
    s_waitcnt lgkmcnt(4)
    v_mfma_f32_32x32x16_bf16 v[52:67], v[100:103], v[104:107], v[52:67]
    s_add_u32 m0, s75, 2048
    s_add_u32 s83, s83, 98304
    buffer_load_dwordx4 v6, s[44:47], s83 offen lds
    v_mfma_f32_32x32x16_bf16 v[84:99], v[100:103], v[108:111], v[84:99]
    s_waitcnt vmcnt(2)
    ds_read_b64_tr_b16 v[100:101], v10 offset:0
    ds_read_b64_tr_b16 v[102:103], v10 offset:256
    ds_read_b128 v[104:107], v26 offset:0
    ds_read_b128 v[108:111], v26 offset:4096
    s_waitcnt lgkmcnt(4)
    v_mfma_f32_32x32x16_bf16 v[52:67], v[116:119], v[120:123], v[52:67]
    s_barrier
    ds_read_b128 v[12:15], v28 offset:0
    ds_read_b128 v[16:19], v28 offset:2048
    ds_read_b128 v[112:115], v28 offset:32768
    ds_read_b128 v[128:131], v28 offset:34816
    s_add_u32 m0, s75, 3072
    s_add_u32 s83, s83, 32768
    buffer_load_dwordx4 v6, s[44:47], s83 offen lds
    v_mfma_f32_32x32x16_bf16 v[84:99], v[116:119], v[124:127], v[84:99]
    s_waitcnt lgkmcnt(3)
    v_mfma_f32_16x16x32_bf16 v[68:71], v[132:135], v[12:15], v[68:71]
    s_waitcnt lgkmcnt(2)
    v_mfma_f32_16x16x32_bf16 v[72:75], v[132:135], v[16:19], v[72:75]
    s_waitcnt lgkmcnt(1)
    v_mfma_f32_16x16x32_bf16 v[68:71], v[136:139], v[112:115], v[68:71]
    s_waitcnt lgkmcnt(0)
    v_mfma_f32_16x16x32_bf16 v[72:75], v[136:139], v[128:131], v[72:75]
    s_waitcnt vmcnt(2)
    ds_read_b64_tr_b16 v[116:117], v10 offset:1024
    ds_read_b64_tr_b16 v[118:119], v10 offset:1280
    ds_read_b128 v[120:123], v27 offset:0
    ds_read_b128 v[124:127], v27 offset:4096
    s_waitcnt lgkmcnt(4)
    v_mfma_f32_32x32x16_bf16 v[52:67], v[100:103], v[104:107], v[52:67]
    s_bfe_u32 s83, s82, 0x30008
    s_add_u32 m0, s75, 0
    s_lshl_b32 s83, s83, 18
    buffer_load_dwordx4 v6, s[44:47], s83 offen lds
    v_mfma_f32_32x32x16_bf16 v[84:99], v[100:103], v[108:111], v[84:99]
    s_cmp_ge_u32 s5, 4
    s_cbranch_scc1 L_kwv
    ds_write_b128 v30, v[68:71]
    ds_write_b128 v30, v[72:75] offset:1024
    s_branch L_kwj
L_kwv:
    ds_write_b32 v30, v68 offset:0
    ds_write_b32 v30, v69 offset:128
    ds_write_b32 v30, v70 offset:256
    ds_write_b32 v30, v71 offset:384
    ds_write_b32 v30, v72 offset:64
    ds_write_b32 v30, v73 offset:192
    ds_write_b32 v30, v74 offset:320
    ds_write_b32 v30, v75 offset:448
L_kwj:
    s_waitcnt lgkmcnt(0)
    s_barrier
    s_waitcnt vmcnt(2)
    ds_read_b64_tr_b16 v[100:101], v10 offset:2048
    ds_read_b64_tr_b16 v[102:103], v10 offset:2304
    ds_read_b128 v[104:107], v26 offset:8192
    ds_read_b128 v[108:111], v26 offset:12288
    s_waitcnt lgkmcnt(4)
    v_mfma_f32_32x32x16_bf16 v[52:67], v[116:119], v[120:123], v[52:67]
    s_add_u32 m0, s75, 1024
    s_add_u32 s83, s83, 32768
    buffer_load_dwordx4 v6, s[44:47], s83 offen lds
    v_mfma_f32_32x32x16_bf16 v[84:99], v[116:119], v[124:127], v[84:99]
    s_waitcnt vmcnt(2)
    ds_read_b64_tr_b16 v[116:117], v10 offset:3072
    ds_read_b64_tr_b16 v[118:119], v10 offset:3328
    ds_read_b128 v[120:123], v27 offset:8192
    ds_read_b128 v[124:127], v27 offset:12288
    s_waitcnt lgkmcnt(4)
    v_mfma_f32_32x32x16_bf16 v[52:67], v[100:103], v[104:107], v[52:67]
    s_barrier
    s_add_u32 m0, s87, 1024
    s_add_u32 s83, s83, 98304
    buffer_load_dwordx4 v6, s[44:47], s83 offen lds
    s_add_u32 m0, s87, 0
    s_add_u32 s83, s83, 32768
    buffer_load_dwordx4 v6, s[44:47], s83 offen lds
    v_mfma_f32_32x32x16_bf16 v[84:99], v[100:103], v[108:111], v[84:99]
    s_waitcnt vmcnt(3)
    ds_read_b64_tr_b16 v[100:101], v10 offset:0
    ds_read_b64_tr_b16 v[102:103], v10 offset:256
    ds_read_b128 v[104:107], v26 offset:16384
    ds_read_b128 v[108:111], v26 offset:20480
    s_waitcnt lgkmcnt(4)
    v_mfma_f32_32x32x16_bf16 v[52:67], v[116:119], v[120:123], v[52:67]
    s_bfe_u32 s83, s82, 0x3000c
    s_add_u32 m0, s75, 2048
    s_lshl_b32 s83, s83, 18
    buffer_load_dwordx4 v6, s[44:47], s83 offen lds
    v_mfma_f32_32x32x16_bf16 v[84:99], v[116:119], v[124:127], v[84:99]
    s_waitcnt vmcnt(3)
    ds_read_b64_tr_b16 v[116:117], v10 offset:1024
    ds_read_b64_tr_b16 v[118:119], v10 offset:1280
    ds_read_b128 v[120:123], v27 offset:16384
    ds_read_b128 v[124:127], v27 offset:20480
    s_waitcnt lgkmcnt(4)
    v_mfma_f32_32x32x16_bf16 v[52:67], v[100:103], v[104:107], v[52:67]
    s_add_u32 m0, s75, 3072
    s_add_u32 s83, s83, 32768
    buffer_load_dwordx4 v6, s[44:47], s83 offen lds
    v_mfma_f32_32x32x16_bf16 v[84:99], v[100:103], v[108:111], v[84:99]
    s_waitcnt vmcnt(3)
    ds_read_b64_tr_b16 v[100:101], v35 offset:1024
    ds_read_b64_tr_b16 v[102:103], v35 offset:1280
    ds_read_b128 v[104:107], v26 offset:24576
    ds_read_b128 v[108:111], v26 offset:28672
    s_waitcnt lgkmcnt(4)
    v_mfma_f32_32x32x16_bf16 v[52:67], v[116:119], v[120:123], v[52:67]
    s_add_u32 m0, s75, 0
    s_add_u32 s83, s83, 98304
    buffer_load_dwordx4 v6, s[44:47], s83 offen lds
    v_mfma_f32_32x32x16_bf16 v[84:99], v[116:119], v[124:127], v[84:99]
    s_waitcnt vmcnt(3)
    ds_read_b64_tr_b16 v[116:117], v35 offset:0
    ds_read_b64_tr_b16 v[118:119], v35 offset:256
    ds_read_b128 v[120:123], v27 offset:24576
    ds_read_b128 v[124:127], v27 offset:28672
    s_waitcnt lgkmcnt(4)
    v_mfma_f32_32x32x16_bf16 v[52:67], v[100:103], v[104:107], v[52:67]
    s_add_u32 m0, s75, 1024
    s_add_u32 s83, s83, 32768
    buffer_load_dwordx4 v6, s[44:47], s83 offen lds
    v_mfma_f32_32x32x16_bf16 v[84:99], v[100:103], v[108:111], v[84:99]
    s_waitcnt vmcnt(3)
    ds_read_b64_tr_b16 v[100:101], v10 offset:2048
    ds_read_b64_tr_b16 v[102:103], v10 offset:2304
    ds_read_b128 v[104:107], v26 offset:32768
    ds_read_b128 v[108:111], v26 offset:36864
    s_waitcnt lgkmcnt(4)
    v_mfma_f32_32x32x16_bf16 v[52:67], v[116:119], v[120:123], v[52:67]
    s_bfe_u32 s83, s82, 0x30010
    s_add_u32 m0, s87, 1024
    s_lshl_b32 s83, s83, 18
    buffer_load_dwordx4 v6, s[44:47], s83 offen lds
    v_mfma_f32_32x32x16_bf16 v[84:99], v[116:119], v[124:127], v[84:99]
    v_mov_b32 v44, 0
    v_mov_b32 v45, 0
    v_mov_b32 v46, 0
    v_mov_b32 v47, 0
    s_waitcnt vmcnt(3)
    ds_read_b64_tr_b16 v[116:117], v10 offset:3072
    ds_read_b64_tr_b16 v[118:119], v10 offset:3328
    ds_read_b128 v[120:123], v27 offset:32768
    ds_read_b128 v[124:127], v27 offset:36864
    s_waitcnt lgkmcnt(4)
    v_mfma_f32_32x32x16_bf16 v[52:67], v[100:103], v[104:107], v[52:67]
    s_add_u32 m0, s87, 0
    s_add_u32 s83, s83, 32768
    buffer_load_dwordx4 v6, s[44:47], s83 offen lds
    v_mfma_f32_32x32x16_bf16 v[84:99], v[100:103], v[108:111], v[84:99]
    v_mov_b32 v48, 0
    v_mov_b32 v49, 0
    v_mov_b32 v50, 0
    v_mov_b32 v51, 0
    s_waitcnt vmcnt(3)
    ds_read_b64_tr_b16 v[100:101], v10 offset:0
    ds_read_b64_tr_b16 v[102:103], v10 offset:256
    ds_read_b128 v[104:107], v26 offset:40960
    ds_read_b128 v[108:111], v26 offset:45056
    s_waitcnt lgkmcnt(4)
    v_mfma_f32_32x32x16_bf16 v[52:67], v[116:119], v[120:123], v[52:67]
    s_add_u32 m0, s75, 2048
    s_add_u32 s83, s83, 98304
    buffer_load_dwordx4 v6, s[44:47], s83 offen lds
    v_mfma_f32_32x32x16_bf16 v[84:99], v[116:119], v[124:127], v[84:99]
    v_mov_b32 v148, 0
    v_mov_b32 v149, 0
    v_mov_b32 v150, 0
    v_mov_b32 v151, 0
    s_waitcnt vmcnt(3)
    ds_read_b64_tr_b16 v[116:117], v10 offset:1024
    ds_read_b64_tr_b16 v[118:119], v10 offset:1280
    ds_read_b128 v[120:123], v27 offset:40960
    ds_read_b128 v[124:127], v27 offset:45056
    s_waitcnt lgkmcnt(4)
    v_mfma_f32_32x32x16_bf16 v[52:67], v[100:103], v[104:107], v[52:67]
    s_add_u32 m0, s75, 3072
    s_add_u32 s83, s83, 32768
    buffer_load_dwordx4 v6, s[44:47], s83 offen lds
    v_mfma_f32_32x32x16_bf16 v[84:99], v[100:103], v[108:111], v[84:99]
    v_mov_b32 v152, 0
    v_mov_b32 v153, 0
    v_mov_b32 v154, 0
    v_mov_b32 v155, 0
    s_waitcnt vmcnt(3)
    v_add_u32 v26, 0x10000, v26
    v_add_u32 v27, 0x10000, v27
    ds_read_b64_tr_b16 v[100:101], v35 offset:1024
    ds_read_b64_tr_b16 v[102:103], v35 offset:1280
    ds_read_b128 v[104:107], v26 offset:0
    ds_read_b128 v[108:111], v26 offset:4096
    s_waitcnt lgkmcnt(4)
    v_mfma_f32_32x32x16_bf16 v[52:67], v[116:119], v[120:123], v[52:67]
    s_bfe_u32 s83, s82, 0x30014
    s_add_u32 m0, s75, 0
    s_lshl_b32 s83, s83, 18
    buffer_load_dwordx4 v6, s[44:47], s83 offen lds
    v_mfma_f32_32x32x16_bf16 v[84:99], v[116:119], v[124:127], v[84:99]
    v_mov_b32 v156, 0
    v_mov_b32 v157, 0
    v_mov_b32 v158, 0
    v_mov_b32 v159, 0
    s_waitcnt vmcnt(3)
    ds_read_b64_tr_b16 v[116:117], v35 offset:0
    ds_read_b64_tr_b16 v[118:119], v35 offset:256
    ds_read_b128 v[120:123], v27 offset:0
    ds_read_b128 v[124:127], v27 offset:4096
    s_waitcnt lgkmcnt(4)
    v_mfma_f32_32x32x16_bf16 v[52:67], v[100:103], v[104:107], v[52:67]
    s_add_u32 m0, s75, 1024
    s_add_u32 s83, s83, 32768
    buffer_load_dwordx4 v6, s[44:47], s83 offen lds
    v_mfma_f32_32x32x16_bf16 v[84:99], v[100:103], v[108:111], v[84:99]
    v_mov_b32 v160, 0
    v_mov_b32 v161, 0
    v_mov_b32 v162, 0
    v_mov_b32 v163, 0
    s_waitcnt vmcnt(3)
    ds_read_b64_tr_b16 v[100:101], v10 offset:2048
    ds_read_b64_tr_b16 v[102:103], v10 offset:2304
    ds_read_b128 v[104:107], v26 offset:8192
    ds_read_b128 v[108:111], v26 offset:12288
    s_waitcnt lgkmcnt(4)
    v_mfma_f32_32x32x16_bf16 v[52:67], v[116:119], v[120:123], v[52:67]
    s_add_u32 m0, s87, 1024
    s_add_u32 s83, s83, 98304
    buffer_load_dwordx4 v6, s[44:47], s83 offen lds
    v_mfma_f32_32x32x16_bf16 v[84:99], v[116:119], v[124:127], v[84:99]
    v_mov_b32 v132, 0
    v_mov_b32 v133, 0
    v_mov_b32 v134, 0
    v_mov_b32 v135, 0
    s_waitcnt vmcnt(3)
    ds_read_b64_tr_b16 v[116:117], v10 offset:3072
    ds_read_b64_tr_b16 v[118:119], v10 offset:3328
    ds_read_b128 v[120:123], v27 offset:8192
    ds_read_b128 v[124:127], v27 offset:12288
    s_waitcnt lgkmcnt(4)
    v_mfma_f32_32x32x16_bf16 v[52:67], v[100:103], v[104:107], v[52:67]
    s_add_u32 m0, s87, 0
    s_add_u32 s83, s83, 32768
    buffer_load_dwordx4 v6, s[44:47], s83 offen lds
    v_mfma_f32_32x32x16_bf16 v[84:99], v[100:103], v[108:111], v[84:99]
    v_mov_b32 v136, 0
    v_mov_b32 v137, 0
    v_mov_b32 v138, 0
    v_mov_b32 v139, 0
    s_waitcnt vmcnt(3)
    ds_read_b64_tr_b16 v[100:101], v10 offset:0
    ds_read_b64_tr_b16 v[102:103], v10 offset:256
    ds_read_b128 v[104:107], v26 offset:16384
    ds_read_b128 v[108:111], v26 offset:20480
    s_waitcnt lgkmcnt(4)
    v_mfma_f32_32x32x16_bf16 v[52:67], v[116:119], v[120:123], v[52:67]
    s_bfe_u32 s83, s82, 0x30018
    s_add_u32 m0, s75, 2048
    s_lshl_b32 s83, s83, 18
    buffer_load_dwordx4 v6, s[44:47], s83 offen lds
    v_mfma_f32_32x32x16_bf16 v[84:99], v[116:119], v[124:127], v[84:99]
    v_mov_b32 v140, 0
    v_mov_b32 v141, 0
    v_mov_b32 v142, 0
    v_mov_b32 v143, 0
    s_waitcnt vmcnt(3)
    ds_read_b64_tr_b16 v[116:117], v10 offset:1024
    ds_read_b64_tr_b16 v[118:119], v10 offset:1280
    ds_read_b128 v[120:123], v27 offset:16384
    ds_read_b128 v[124:127], v27 offset:20480
    s_waitcnt lgkmcnt(4)
    v_mfma_f32_32x32x16_bf16 v[52:67], v[100:103], v[104:107], v[52:67]
    s_add_u32 m0, s75, 3072
    s_add_u32 s83, s83, 32768
    buffer_load_dwordx4 v6, s[44:47], s83 offen lds
    v_mfma_f32_32x32x16_bf16 v[84:99], v[100:103], v[108:111], v[84:99]
    v_mov_b32 v144, 0
    v_mov_b32 v145, 0
    v_mov_b32 v146, 0
    v_mov_b32 v147, 0
    s_waitcnt vmcnt(3)
    ds_read_b64_tr_b16 v[100:101], v35 offset:1024
    ds_read_b64_tr_b16 v[102:103], v35 offset:1280
    ds_read_b128 v[104:107], v26 offset:24576
    ds_read_b128 v[108:111], v26 offset:28672
    s_waitcnt lgkmcnt(4)
    v_mfma_f32_32x32x16_bf16 v[52:67], v[116:119], v[120:123], v[52:67]
    s_add_u32 m0, s75, 0
    s_add_u32 s83, s83, 98304
    buffer_load_dwordx4 v6, s[44:47], s83 offen lds
    v_mfma_f32_32x32x16_bf16 v[84:99], v[116:119], v[124:127], v[84:99]
    v_mov_b32 v68, 0
    v_mov_b32 v69, 0
    v_mov_b32 v70, 0
    v_mov_b32 v71, 0
    s_waitcnt vmcnt(3)
    ds_read_b64_tr_b16 v[116:117], v35 offset:0
    ds_read_b64_tr_b16 v[118:119], v35 offset:256
    ds_read_b128 v[120:123], v27 offset:24576
    ds_read_b128 v[124:127], v27 offset:28672
    s_waitcnt lgkmcnt(4)
    v_mfma_f32_32x32x16_bf16 v[52:67], v[100:103], v[104:107], v[52:67]
    s_add_u32 m0, s75, 1024
    s_add_u32 s83, s83, 32768
    buffer_load_dwordx4 v6, s[44:47], s83 offen lds
    v_mfma_f32_32x32x16_bf16 v[84:99], v[100:103], v[108:111], v[84:99]
    v_mov_b32 v72, 0
    v_mov_b32 v73, 0
    v_mov_b32 v74, 0
    v_mov_b32 v75, 0
    s_waitcnt vmcnt(3)
    ds_read_b64_tr_b16 v[100:101], v10 offset:2048
    ds_read_b64_tr_b16 v[102:103], v10 offset:2304
    ds_read_b128 v[104:107], v26 offset:32768
    ds_read_b128 v[108:111], v26 offset:36864
    s_waitcnt lgkmcnt(4)
    v_mfma_f32_32x32x16_bf16 v[52:67], v[116:119], v[120:123], v[52:67]
    s_barrier
    s_bfe_u32 s83, s82, 0x3001c
    s_add_u32 m0, s87, 1024
    s_lshl_b32 s83, s83, 18
    buffer_load_dwordx4 v6, s[44:47], s83 offen lds
    v_mfma_f32_32x32x16_bf16 v[84:99], v[116:119], v[124:127], v[84:99]
    v_mov_b32 v76, 0
    v_mov_b32 v77, 0
    v_mov_b32 v78, 0
    v_mov_b32 v79, 0
    s_waitcnt vmcnt(3)
    ds_read_b64_tr_b16 v[116:117], v10 offset:3072
    ds_read_b64_tr_b16 v[118:119], v10 offset:3328
    ds_read_b128 v[120:123], v27 offset:32768
    ds_read_b128 v[124:127], v27 offset:36864
    s_waitcnt lgkmcnt(4)
    v_mfma_f32_32x32x16_bf16 v[52:67], v[100:103], v[104:107], v[52:67]
    s_add_u32 m0, s87, 0
    s_add_u32 s83, s83, 32768
    buffer_load_dwordx4 v6, s[44:47], s83 offen lds
    v_mfma_f32_32x32x16_bf16 v[84:99], v[100:103], v[108:111], v[84:99]
    v_mov_b32 v80, 0
    v_mov_b32 v81, 0
    v_mov_b32 v82, 0
    v_mov_b32 v83, 0
    s_waitcnt vmcnt(3)
    ds_read_b64_tr_b16 v[100:101], v10 offset:0
    ds_read_b64_tr_b16 v[102:103], v10 offset:256
    ds_read_b128 v[104:107], v26 offset:40960
    ds_read_b128 v[108:111], v26 offset:45056
    s_waitcnt lgkmcnt(4)
    v_mfma_f32_32x32x16_bf16 v[52:67], v[116:119], v[120:123], v[52:67]
    s_add_u32 m0, s75, 2048
    s_add_u32 s83, s83, 98304
    buffer_load_dwordx4 v6, s[44:47], s83 offen lds
    v_mfma_f32_32x32x16_bf16 v[84:99], v[116:119], v[124:127], v[84:99]
    s_waitcnt vmcnt(3)
    ds_read_b64_tr_b16 v[116:117], v10 offset:1024
    ds_read_b64_tr_b16 v[118:119], v10 offset:1280
    ds_read_b128 v[120:123], v27 offset:40960
    ds_read_b128 v[124:127], v27 offset:45056
    s_waitcnt lgkmcnt(4)
    v_mfma_f32_32x32x16_bf16 v[52:67], v[100:103], v[104:107], v[52:67]
    s_add_u32 m0, s75, 3072
    s_add_u32 s83, s83, 32768
    buffer_load_dwordx4 v6, s[44:47], s83 offen lds
    v_mfma_f32_32x32x16_bf16 v[84:99], v[100:103], v[108:111], v[84:99]
    s_waitcnt vmcnt(3)
    ds_read_b64_tr_b16 v[100:101], v35 offset:1024
    ds_read_b64_tr_b16 v[102:103], v35 offset:1280
    ds_read_b128 v[104:107], v26 offset:49152
    ds_read_b128 v[108:111], v26 offset:53248
    s_waitcnt vmcnt(2)
    ds_read_b64_tr_b16 v[12:13], v35 offset:0
    ds_read_b64_tr_b16 v[14:15], v35 offset:256
    ds_read_b128 v[16:19], v27 offset:49152
    ds_read_b128 v[112:115], v27 offset:53248
    s_waitcnt lgkmcnt(8)
    v_mfma_f32_32x32x16_bf16 v[52:67], v[116:119], v[120:123], v[52:67]
    v_mfma_f32_32x32x16_bf16 v[84:99], v[116:119], v[124:127], v[84:99]
    s_waitcnt vmcnt(1)
    ds_read_b64_tr_b16 v[116:117], v10 offset:2048
    ds_read_b64_tr_b16 v[118:119], v10 offset:2304
    ds_read_b128 v[120:123], v26 offset:57344
    ds_read_b128 v[124:127], v26 offset:61440
    s_waitcnt lgkmcnt(8)
    v_mfma_f32_32x32x16_bf16 v[52:67], v[100:103], v[104:107], v[52:67]
    v_mfma_f32_32x32x16_bf16 v[84:99], v[100:103], v[108:111], v[84:99]
    s_waitcnt vmcnt(0)
    ds_read_b64_tr_b16 v[100:101], v10 offset:3072
    ds_read_b64_tr_b16 v[102:103], v10 offset:3328
    ds_read_b128 v[104:107], v27 offset:57344
    ds_read_b128 v[108:111], v27 offset:61440
    s_cmp_eq_u32 s73, 0
    s_cbranch_scc0 L_q1
    s_waitcnt lgkmcnt(8)
    v_mfma_f32_32x32x16_bf16 v[84:99], v[12:15], v[112:115], v[84:99]
    s_waitcnt lgkmcnt(4)
    v_mfma_f32_32x32x16_bf16 v[84:99], v[116:119], v[124:127], v[84:99]
    s_waitcnt lgkmcnt(0)
    v_mfma_f32_32x32x16_bf16 v[84:99], v[100:103], v[108:111], v[84:99]
    v_mfma_f32_32x32x16_bf16 v[52:67], v[12:15], v[16:19], v[52:67]
    v_mfma_f32_32x32x16_bf16 v[52:67], v[116:119], v[120:123], v[52:67]
    v_mfma_f32_32x32x16_bf16 v[52:67], v[100:103], v[104:107], v[52:67]
    v_mov_b32 v8, 0xdddddddd
    v_and_b32 v2, 15, v0
    v_cmp_eq_u32 vcc, 0, v2
    v_cmp_eq_u32 s[40:41], 4, v2
    v_mov_b32 v3, 0x3f803f80
    v_mov_b32 v26, v1
    v_add_u32 v27, 16384, v1
    v_cndmask_b32 v28, 0, v3, vcc
    v_cndmask_b32 v29, 0, v3, vcc
    v_cndmask_b32 v30, 0, v3, s[40:41]
    v_cndmask_b32 v31, 0, v3, s[40:41]
    ds_write_b128 v33, v[84:87] offset:0
    ds_write_b128 v33, v[88:91] offset:1024
    ds_write_b128 v33, v[92:95] offset:2048
    ds_write_b128 v33, v[96:99] offset:3072
    s_waitcnt lgkmcnt(0)
    s_barrier
    ds_read_b128 v[84:87], v34 offset:0
    ds_read_b128 v[88:91], v34 offset:1024
    ds_read_b128 v[92:95], v34 offset:2048
    ds_read_b128 v[96:99], v34 offset:3072
    ds_read_b128 v[36:39], v1 offset:0
    ds_read_b128 v[40:43], v1 offset:1024
    ds_read_b128 v[100:103], v1 offset:4096
    ds_read_b128 v[104:107], v1 offset:5120
    s_waitcnt lgkmcnt(7)
    v_pk_add_f32 v[52:53], v[52:53], v[84:85]
    v_pk_add_f32 v[54:55], v[54:55], v[86:87]
    v_cvt_pk_bf16_f32 v12, v52, v53
    v_cvt_pk_bf16_f32 v13, v54, v55
    s_waitcnt lgkmcnt(6)
    v_pk_add_f32 v[56:57], v[56:57], v[88:89]
    v_pk_add_f32 v[58:59], v[58:59], v[90:91]
    v_cvt_pk_bf16_f32 v14, v56, v57
    v_cvt_pk_bf16_f32 v15, v58, v59
    s_waitcnt lgkmcnt(5)
    v_pk_add_f32 v[60:61], v[60:61], v[92:93]
    v_pk_add_f32 v[62:63], v[62:63], v[94:95]
    v_cvt_pk_bf16_f32 v16, v60, v61
    v_cvt_pk_bf16_f32 v17, v62, v63
    s_waitcnt lgkmcnt(4)
    v_pk_add_f32 v[64:65], v[64:65], v[96:97]
    v_pk_add_f32 v[66:67], v[66:67], v[98:99]
    v_cvt_pk_bf16_f32 v18, v64, v65
    v_cvt_pk_bf16_f32 v19, v66, v67
    s_branch L_q2
L_q1:
    s_waitcnt lgkmcnt(8)
    v_mfma_f32_32x32x16_bf16 v[52:67], v[12:15], v[16:19], v[52:67]
    s_waitcnt lgkmcnt(4)
    v_mfma_f32_32x32x16_bf16 v[52:67], v[116:119], v[120:123], v[52:67]
    s_waitcnt lgkmcnt(0)
    v_mfma_f32_32x32x16_bf16 v[52:67], v[100:103], v[104:107], v[52:67]
    v_mfma_f32_32x32x16_bf16 v[84:99], v[12:15], v[112:115], v[84:99]
    v_mfma_f32_32x32x16_bf16 v[84:99], v[116:119], v[124:127], v[84:99]
    v_mfma_f32_32x32x16_bf16 v[84:99], v[100:103], v[108:111], v[84:99]
    v_mov_b32 v8, 0xdddddddd
    v_and_b32 v2, 15, v0
    v_cmp_eq_u32 vcc, 0, v2
    v_cmp_eq_u32 s[40:41], 4, v2
    v_mov_b32 v3, 0x3f803f80
    v_mov_b32 v26, v1
    v_add_u32 v27, 16384, v1
    v_cndmask_b32 v28, 0, v3, vcc
    v_cndmask_b32 v29, 0, v3, vcc
    v_cndmask_b32 v30, 0, v3, s[40:41]
    v_cndmask_b32 v31, 0, v3, s[40:41]
    ds_write_b128 v33, v[52:55] offset:0
    ds_write_b128 v33, v[56:59] offset:1024
    ds_write_b128 v33, v[60:63] offset:2048
    ds_write_b128 v33, v[64:67] offset:3072
    s_waitcnt lgkmcnt(0)
    s_barrier
    ds_read_b128 v[52:55], v34 offset:0
    ds_read_b128 v[56:59], v34 offset:1024
    ds_read_b128 v[60:63], v34 offset:2048
    ds_read_b128 v[64:67], v34 offset:3072
    ds_read_b128 v[36:39], v1 offset:0
    ds_read_b128 v[40:43], v1 offset:1024
    ds_read_b128 v[100:103], v1 offset:4096
    ds_read_b128 v[104:107], v1 offset:5120
    s_waitcnt lgkmcnt(7)
    v_pk_add_f32 v[84:85], v[84:85], v[52:53]
    v_pk_add_f32 v[86:87], v[86:87], v[54:55]
    v_cvt_pk_bf16_f32 v12, v84, v85
    v_cvt_pk_bf16_f32 v13, v86, v87
    s_waitcnt lgkmcnt(6)
    v_pk_add_f32 v[88:89], v[88:89], v[56:57]
    v_pk_add_f32 v[90:91], v[90:91], v[58:59]
    v_cvt_pk_bf16_f32 v14, v88, v89
    v_cvt_pk_bf16_f32 v15, v90, v91
    s_waitcnt lgkmcnt(5)
    v_pk_add_f32 v[92:93], v[92:93], v[60:61]
    v_pk_add_f32 v[94:95], v[94:95], v[62:63]
    v_cvt_pk_bf16_f32 v16, v92, v93
    v_cvt_pk_bf16_f32 v17, v94, v95
    s_waitcnt lgkmcnt(4)
    v_pk_add_f32 v[96:97], v[96:97], v[64:65]
    v_pk_add_f32 v[98:99], v[98:99], v[66:67]
    v_cvt_pk_bf16_f32 v18, v96, v97
    v_cvt_pk_bf16_f32 v19, v98, v99
L_q2:
    s_waitcnt lgkmcnt(0)
    v_mfma_f32_32x32x16_bf16 v[116:131], v[100:103], v[12:15], 0
    v_mfma_f32_32x32x16_bf16 v[116:131], v[104:107], v[16:19], v[116:131]
    v_mfma_f32_32x32x16_bf16 v[100:115], v[36:39], v[12:15], 0
    v_mfma_f32_32x32x16_bf16 v[100:115], v[40:43], v[16:19], v[100:115]
    v_mov_b32 v32, 0
    v_mov_b32 v33, 0
    v_mov_b32 v34, 0
    v_mov_b32 v35, 0
    s_nop 5
    v_max3_f32 v2, v116, v117, v118
    v_max3_f32 v2, v2, v119, v120
    v_max3_f32 v2, v2, v121, v122
    v_max3_f32 v2, v2, v123, v124
    v_max3_f32 v2, v2, v125, v126
    v_max3_f32 v2, v2, v127, v128
    v_max3_f32 v2, v2, v129, v130
    v_max3_f32 v2, v2, v131, v100
    v_max3_f32 v2, v2, v101, v102
    v_max3_f32 v2, v2, v103, v104
    v_max3_f32 v2, v2, v105, v106
    v_max3_f32 v2, v2, v107, v108
    v_max3_f32 v2, v2, v109, v110
    v_max3_f32 v2, v2, v111, v112
    v_max3_f32 v2, v2, v113, v114
    v_max_f32 v2, v2, v115
    v_mov_b32 v3, v2
    s_mov_b32 s77, 0
    s_mov_b32 s78, 16384
    v_permlane32_swap_b32 v2, v3
    v_max_f32 v2, v2, v3
    v_sub_f32 v2, 0xc2c00000, v2
    v_mov_b32 v52, v2
    v_mov_b32 v53, v2
    v_mov_b32 v54, v2
    v_mov_b32 v55, v2
    v_mov_b32 v56, v2
    v_mov_b32 v57, v2
    v_mov_b32 v58, v2
    v_mov_b32 v59, v2
    v_mov_b32 v60, v2
    v_mov_b32 v61, v2
    v_mov_b32 v62, v2
    v_mov_b32 v63, v2
    v_mov_b32 v64, v2
    v_mov_b32 v65, v2
    v_mov_b32 v66, v2
    v_mov_b32 v67, v2
    s_nop 1
    v_mfma_f32_32x32x16_bf16 v[100:115], v[36:39], v[12:15], v[52:67]
    v_mfma_f32_32x32x16_bf16 v[100:115], v[40:43], v[16:19], v[100:115]
    ds_read_b128 v[36:39], v1 offset:4096
    ds_read_b128 v[40:43], v1 offset:5120
    s_nop 6
    s_waitcnt lgkmcnt(0)
    s_mov_b32 s98, 5
L_attn:
    s_waitcnt lgkmcnt(2)
    v_mfma_f32_32x32x16_bf16 v[116:131], v[36:39], v[12:15], v[52:67]
    v_exp_f32 v100, v100
    v_exp_f32 v101, v101
    v_exp_f32 v102, v102
    v_mfma_f32_32x32x16_bf16 v[116:131], v[40:43], v[16:19], v[116:131]
    s_setprio 1
    ds_read_b128 v[36:39], v26 offset:8192
    ds_read_b128 v[40:43], v26 offset:9216
    v_exp_f32 v103, v103
    v_exp_f32 v104, v104
    v_exp_f32 v105, v105
    v_smfmac_f32_16x16x64_bf16 v[32:35], v[28:31], v[132:139], v8
    v_exp_f32 v106, v106
    v_exp_f32 v107, v107
    v_exp_f32 v108, v108
    s_waitcnt lgkmcnt(2)
    v_smfmac_f32_32x32x32_bf16 v[148:163], v[44:47], v[132:139], v8
    v_exp_f32 v109, v109
    v_exp_f32 v110, v110
    v_exp_f32 v111, v111
    v_smfmac_f32_16x16x64_bf16 v[32:35], v[28:31], v[140:147], v8
    v_exp_f32 v112, v112
    v_smfmac_f32_32x32x32_bf16 v[148:163], v[48:51], v[140:147], v8
    v_exp_f32 v113, v113
    ds_read_b128 v[44:47], v26 offset:2048
    ds_read_b128 v[48:51], v26 offset:3072
    v_exp_f32 v114, v114
    v_exp_f32 v115, v115
    s_waitcnt lgkmcnt(2)
    v_mfma_f32_32x32x16_bf16 v[84:99], v[36:39], v[12:15], v[52:67]
    v_exp_f32 v116, v116
    v_exp_f32 v117, v117
    v_exp_f32 v118, v118
    v_mfma_f32_32x32x16_bf16 v[84:99], v[40:43], v[16:19], v[84:99]
    s_setprio 0
    ds_read_b128 v[36:39], v26 offset:12288
    ds_read_b128 v[40:43], v26 offset:13312
    v_exp_f32 v119, v119
    v_exp_f32 v120, v120
    v_exp_f32 v121, v121
    v_smfmac_f32_16x16x64_bf16 v[32:35], v[28:31], v[100:107], v8
    v_exp_f32 v122, v122
    v_exp_f32 v123, v123
    v_exp_f32 v124, v124
    s_waitcnt lgkmcnt(2)
    v_smfmac_f32_32x32x32_bf16 v[148:163], v[44:47], v[100:107], v8
    v_exp_f32 v125, v125
    v_exp_f32 v126, v126
    v_exp_f32 v127, v127
    v_smfmac_f32_16x16x64_bf16 v[32:35], v[28:31], v[108:115], v8
    v_exp_f32 v128, v128
    v_smfmac_f32_32x32x32_bf16 v[148:163], v[48:51], v[108:115], v8
    v_exp_f32 v129, v129
    ds_read_b128 v[44:47], v26 offset:6144
    ds_read_b128 v[48:51], v26 offset:7168
    v_exp_f32 v130, v130
    v_exp_f32 v131, v131
    s_waitcnt lgkmcnt(2)
    v_mfma_f32_32x32x16_bf16 v[132:147], v[36:39], v[12:15], v[52:67]
    v_exp_f32 v84, v84
    v_exp_f32 v85, v85
    v_exp_f32 v86, v86
    v_mfma_f32_32x32x16_bf16 v[132:147], v[40:43], v[16:19], v[132:147]
    s_barrier
    s_setprio 3
    ds_read_b128 v[36:39], v27 offset:0
    ds_read_b128 v[40:43], v27 offset:1024
    v_exp_f32 v87, v87
    v_exp_f32 v88, v88
    v_exp_f32 v89, v89
    v_smfmac_f32_16x16x64_bf16 v[32:35], v[28:31], v[116:123], v8
    v_exp_f32 v90, v90
    v_exp_f32 v91, v91
    v_exp_f32 v92, v92
    s_waitcnt lgkmcnt(2)
    v_smfmac_f32_32x32x32_bf16 v[148:163], v[44:47], v[116:123], v8
    v_exp_f32 v93, v93
    v_exp_f32 v94, v94
    v_exp_f32 v95, v95
    v_smfmac_f32_16x16x64_bf16 v[32:35], v[28:31], v[124:131], v8
    v_exp_f32 v96, v96
    v_smfmac_f32_32x32x32_bf16 v[148:163], v[48:51], v[124:131], v8
    v_exp_f32 v97, v97
    ds_read_b128 v[44:47], v26 offset:10240
    ds_read_b128 v[48:51], v26 offset:11264
    v_exp_f32 v98, v98
    v_exp_f32 v99, v99
    s_waitcnt lgkmcnt(2)
    v_mfma_f32_32x32x16_bf16 v[100:115], v[36:39], v[12:15], v[52:67]
    v_exp_f32 v132, v132
    v_exp_f32 v133, v133
    v_exp_f32 v134, v134
    v_mfma_f32_32x32x16_bf16 v[100:115], v[40:43], v[16:19], v[100:115]
    s_setprio 2
    ds_read_b128 v[36:39], v27 offset:4096
    ds_read_b128 v[40:43], v27 offset:5120
    v_exp_f32 v135, v135
    v_exp_f32 v136, v136
    v_exp_f32 v137, v137
    v_smfmac_f32_16x16x64_bf16 v[32:35], v[28:31], v[84:91], v8
    v_exp_f32 v138, v138
    v_exp_f32 v139, v139
    v_exp_f32 v140, v140
    s_waitcnt lgkmcnt(2)
    v_smfmac_f32_32x32x32_bf16 v[148:163], v[44:47], v[84:91], v8
    v_exp_f32 v141, v141
    v_exp_f32 v142, v142
    v_exp_f32 v143, v143
    v_smfmac_f32_16x16x64_bf16 v[32:35], v[28:31], v[92:99], v8
    v_exp_f32 v144, v144
    v_smfmac_f32_32x32x32_bf16 v[148:163], v[48:51], v[92:99], v8
    v_exp_f32 v145, v145
    ds_read_b128 v[44:47], v26 offset:14336
    ds_read_b128 v[48:51], v26 offset:15360
    v_mov_b32 v26, v27
    s_add_u32 s78, s78, 16384
    s_cmp_eq_u32 s78, 49152
    s_cselect_b32 s78, 0, s78
    s_add_u32 s77, s77, 1
    v_add_u32 v27, s78, v1
    s_cmp_lg_u32 s77, s98
    v_exp_f32 v146, v146
    v_exp_f32 v147, v147
    s_cbranch_scc1 L_attn
    s_cmp_eq_u32 s77, 16
    s_cbranch_scc0 L_pause
    s_setprio 0
    s_waitcnt lgkmcnt(0)
    v_add_u32 v20, 65536, v1
    ds_read_b128 v[36:39], v20 offset:15360
    v_smfmac_f32_32x32x32_bf16 v[148:163], v[44:47], v[132:139], v8
    v_smfmac_f32_16x16x64_bf16 v[32:35], v[28:31], v[132:139], v8
    v_smfmac_f32_32x32x32_bf16 v[148:163], v[48:51], v[140:147], v8
    v_smfmac_f32_16x16x64_bf16 v[32:35], v[28:31], v[140:147], v8
    ds_read_b128 v[44:47], v20
    s_lshl_b32 s8, s3, 8
    s_lshl_b32 s9, s3, 12
    s_waitcnt lgkmcnt(1)
    v_add_u32 v36, s8, v36
    v_readfirstlane_b32 s85, v39
    v_add_u32 v38, s9, v38
    v_and_b32 v39, -2, v39
    s_lshl_b32 s8, s3, 3
    v_xor_b32 v37, s8, v37
    v_xor_b32 v40, 64, v36
    v_xor_b32 v41, 128, v36
    v_xor_b32 v42, 192, v36
    ds_read_b64_tr_b16 v[100:101], v36
    ds_read_b64_tr_b16 v[102:103], v36 offset:8192
    ds_read_b64_tr_b16 v[104:105], v40
    ds_read_b64_tr_b16 v[106:107], v40 offset:8192
    ds_read_b64_tr_b16 v[108:109], v41
    ds_read_b64_tr_b16 v[110:111], v41 offset:8192
    ds_read_b64_tr_b16 v[112:113], v42
    ds_read_b64_tr_b16 v[114:115], v42 offset:8192
    v_xor_b32 v43, 32, v38
    v_mov_b32 v33, v32
    s_nop 1
    v_permlane32_swap_b32 v32, v33
    v_add_f32 v2, abs(v148), abs(v149)
    v_add_f32 v3, abs(v150), abs(v151)
    v_add_f32 v2, v2, abs(v152)
    v_add_f32 v3, v3, abs(v153)
    v_add_f32 v2, v2, abs(v154)
    v_add_f32 v3, v3, abs(v155)
    v_add_f32 v2, v2, abs(v156)
    v_add_f32 v3, v3, abs(v157)
    v_add_f32 v2, v2, abs(v158)
    v_add_f32 v3, v3, abs(v159)
    v_add_f32 v2, v2, abs(v160)
    v_add_f32 v3, v3, abs(v161)
    v_add_f32 v2, v2, abs(v162)
    v_add_f32 v3, v3, abs(v163)
    s_mov_b32 s8, 0xd800000
    s_mov_b32 s9, 0x7e800000
    v_add_f32 v2, v2, v3
    v_cmp_nlt_f32 vcc, v32, s9
    v_rcp_f32 v9, v32
    v_cmp_nge_f32 s[40:41], v2, s8
    v_cmp_nlt_f32 s[42:43], v2, s9
    s_or_b64 s[40:41], s[40:41], vcc
    s_or_b64 s[40:41], s[40:41], s[42:43]
    s_cbranch_scc1 L_fallback
L_fin:
    s_waitcnt lgkmcnt(0)
    v_mfma_f32_32x32x16_bf16 v[116:131], v[44:47], v[100:103], 0
    v_mul_f32 v148, v148, v9
    v_mul_f32 v149, v149, v9
    v_mul_f32 v150, v150, v9
    v_mul_f32 v151, v151, v9
    v_mul_f32 v152, v152, v9
    v_mul_f32 v153, v153, v9
    v_mul_f32 v154, v154, v9
    v_mul_f32 v155, v155, v9
    v_mfma_f32_32x32x16_bf16 v[84:99], v[44:47], v[104:107], 0
    v_mul_f32 v156, v156, v9
    v_mul_f32 v157, v157, v9
    v_mul_f32 v158, v158, v9
    v_mul_f32 v159, v159, v9
    v_mul_f32 v160, v160, v9
    v_mul_f32 v161, v161, v9
    v_mul_f32 v162, v162, v9
    v_mul_f32 v163, v163, v9
    v_cvt_pk_bf16_f32 v12, v148, v149
    v_mfma_f32_32x32x16_bf16 v[132:147], v[44:47], v[108:111], 0
    v_cvt_pk_bf16_f32 v13, v150, v151
    v_cvt_pk_bf16_f32 v14, v152, v153
    v_cvt_pk_bf16_f32 v15, v154, v155
    v_cvt_pk_bf16_f32 v16, v156, v157
    v_cvt_pk_bf16_f32 v17, v158, v159
    v_cvt_pk_bf16_f32 v18, v160, v161
    v_cvt_pk_bf16_f32 v19, v162, v163
    s_lshl_b32 s8, s5, 2
    s_add_u32 s8, s8, s72
    s_lshl_b32 s8, s8, 12
    s_lshl_b32 s9, s73, 10
    s_add_u32 s8, s8, s9
    s_lshl_b32 s9, s4, 17
    s_add_u32 s8, s8, s9
    s_add_u32 s8, s8, 6291456
    v_mfma_f32_32x32x16_bf16 v[68:83], v[44:47], v[112:115], 0
    s_bitcmp1_b32 s85, 0
    s_cbranch_scc1 L_ofast
    buffer_store_dwordx4 v[12:15], v1, s[60:63], s8 offen sc1
    buffer_store_dwordx4 v[16:19], v1, s[60:63], s8 offen offset:2048 sc1
    s_branch L_oj
L_ofast:
    buffer_store_dwordx4 v[12:15], v1, s[60:63], s8 offen nt
    buffer_store_dwordx4 v[16:19], v1, s[60:63], s8 offen offset:2048 nt
L_oj:
    ds_read_b128 v[52:55], v20 offset:1024
    ds_read_b128 v[56:59], v20 offset:2048
    ds_read_b128 v[60:63], v20 offset:3072
    ds_read_b128 v[64:67], v20 offset:4096
    ds_read_b128 v[28:31], v20 offset:5120
    ds_read_b128 v[32:35], v20 offset:6144
    v_cvt_pk_bf16_f32 v100, v116, v84
    s_nop 0
    v_cvt_pk_bf16_f32 v101, v132, v68
    ds_write_b64 v37, v[100:101] offset:0
    v_cvt_pk_bf16_f32 v102, v117, v85
    v_cvt_pk_bf16_f32 v103, v133, v69
    ds_write_b64 v37, v[102:103] offset:2048
    v_cvt_pk_bf16_f32 v104, v118, v86
    v_cvt_pk_bf16_f32 v105, v134, v70
    ds_write_b64 v37, v[104:105] offset:4096
    v_cvt_pk_bf16_f32 v106, v119, v87
    v_cvt_pk_bf16_f32 v107, v135, v71
    ds_write_b64 v37, v[106:107] offset:6144
    v_cvt_pk_bf16_f32 v108, v120, v88
    v_cvt_pk_bf16_f32 v109, v136, v72
    ds_write_b64 v37, v[108:109] offset:16384
    v_cvt_pk_bf16_f32 v110, v121, v89
    v_cvt_pk_bf16_f32 v111, v137, v73
    ds_write_b64 v37, v[110:111] offset:18432
    v_cvt_pk_bf16_f32 v112, v122, v90
    v_cvt_pk_bf16_f32 v113, v138, v74
    ds_write_b64 v37, v[112:113] offset:20480
    v_cvt_pk_bf16_f32 v114, v123, v91
    v_cvt_pk_bf16_f32 v115, v139, v75
    ds_write_b64 v37, v[114:115] offset:22528
    s_waitcnt lgkmcnt(0) vmcnt(0)
    s_barrier
    ds_read_b128 v[100:103], v38
    ds_read_b128 v[108:111], v38 offset:2048
    ds_read_b128 v[104:107], v43
    ds_read_b128 v[112:115], v43 offset:2048
    s_lshl_b32 s8, s72, 12
    s_lshl_b32 s9, s73, 10
    s_add_u32 s8, s8, s9
    s_add_u32 s8, s8, 0
    v_add_u32 v2, s8, v1
    s_lshl_b32 s100, s5, 1
    s_lshl_b32 s8, s3, 12
    s_add_u32 s8, s8, 98304-131072
    v_add_u32 v10, s8, v10
    s_add_u32 s75, s75, s8
    s_lshl_b32 s87, s72, 12
    s_lshl_b32 s8, s73, 15
    s_add_u32 s87, s87, s8
    s_add_u32 s87, s87, 49152
    s_sub_u32 s8, s87, s75
    v_add_u32 v41, s8, v10
    s_lshl_b32 s8, s73, 12
    v_add_u32 v36, s8, v1
    v_add_u32 v42, 65536, v36
    s_lshl_b32 s8, s4, 17
    s_add_u32 s8, s8, 6291456
    s_add_u32 s40, s36, s8
    s_addc_u32 s41, s37, 0
    s_mov_b32 s42, 131072
    s_mov_b32 s43, 0x20000
    v_add_u32 v5, s74, v1
    s_lshl_b32 s9, s3, 8
    s_add_u32 s9, s9, s11
    s_lshl_b32 s80, s9, 12
    s_waitcnt lgkmcnt(2)
    v_mfma_f32_32x32x16_bf16 v[148:163], v[100:103], v[52:55], 0
    ds_write_b128 v2, v[12:15]
    ds_write_b128 v2, v[16:19] offset:2048
    v_mfma_f32_32x32x16_bf16 v[116:131], v[100:103], v[60:63], 0
    ds_read_b128 v[84:87], v20 offset:7168
    ds_read_b128 v[88:91], v20 offset:8192
    ds_read_b128 v[132:135], v20 offset:9216
    ds_read_b128 v[136:139], v20 offset:10240
    v_mfma_f32_32x32x16_bf16 v[148:163], v[108:111], v[28:31], v[148:163]
    ds_read_b128 v[92:95], v20 offset:11264
    ds_read_b128 v[96:99], v20 offset:12288
    ds_read_b128 v[140:143], v20 offset:13312
    ds_read_b128 v[144:147], v20 offset:14336
    v_mfma_f32_32x32x16_bf16 v[116:131], v[108:111], v[52:55], v[116:131]
    s_waitcnt lgkmcnt(10)
    v_mfma_f32_32x32x16_bf16 v[148:163], v[104:107], v[56:59], v[148:163]
    s_xor_b32 s83, s100, 4
    s_add_u32 m0, s87, 0
    s_lshl_b32 s83, s83, 17
    buffer_load_dwordx4 v6, s[68:71], s83 offen lds
    v_mfma_f32_32x32x16_bf16 v[116:131], v[104:107], v[64:67], v[116:131]
    s_add_u32 m0, s87, 1024
    s_add_u32 s83, s83, 32768
    buffer_load_dwordx4 v6, s[68:71], s83 offen lds
    v_mfma_f32_32x32x16_bf16 v[148:163], v[112:115], v[32:35], v[148:163]
    s_xor_b32 s83, s100, 5
    s_add_u32 m0, s87, 2048
    s_lshl_b32 s83, s83, 17
    buffer_load_dwordx4 v6, s[68:71], s83 offen lds
    v_mfma_f32_32x32x16_bf16 v[116:131], v[112:115], v[56:59], v[116:131]
    s_add_u32 m0, s87, 3072
    s_add_u32 s83, s83, 32768
    buffer_load_dwordx4 v6, s[68:71], s83 offen lds
    s_waitcnt lgkmcnt(0)
    s_barrier
    s_cmp_eq_u32 s73, 0
    s_cbranch_scc1 L_op
    s_setprio 1
L_op:
    s_xor_b32 s76, s100, 2
    s_add_u32 m0, s74, 16384
    s_lshl_b32 s76, s76, 13
    buffer_load_dwordx4 v5, s[40:43], s76 offen sc1 lds
    ds_read_b64_tr_b16 v[60:61], v10 offset:0
    ds_read_b64_tr_b16 v[62:63], v10 offset:256
    ds_read_b128 v[64:67], v36 offset:0
    ds_read_b128 v[12:15], v36 offset:1024
    ds_read_b64_tr_b16 v[16:17], v10 offset:1024
    ds_read_b64_tr_b16 v[18:19], v10 offset:1280
    ds_read_b128 v[164:167], v36 offset:2048
    ds_read_b128 v[20:23], v36 offset:3072
    v_mul_f32 v44, v148, v92
    v_mul_f32 v45, v149, v93
    v_mul_f32 v46, v150, v94
    v_mul_f32 v47, v151, v95
    s_xor_b32 s76, s100, 3
    s_add_u32 m0, s74, 24576
    s_lshl_b32 s76, s76, 13
    buffer_load_dwordx4 v5, s[40:43], s76 offen sc1 lds
    v_mul_f32 v48, v152, v96
    v_mul_f32 v49, v153, v97
    v_mul_f32 v50, v154, v98
    v_mul_f32 v51, v155, v99
    v_mul_f32 v148, v148, v84
    v_mul_f32 v149, v149, v85
    s_xor_b32 s76, s100, 4
    s_add_u32 m0, s74, 32768
    s_lshl_b32 s76, s76, 13
    buffer_load_dwordx4 v5, s[40:43], s76 offen sc1 lds
    v_mul_f32 v150, v150, v86
    v_mul_f32 v151, v151, v87
    v_mul_f32 v152, v152, v88
    v_mul_f32 v153, v153, v89
    v_mul_f32 v154, v154, v90
    v_mul_f32 v155, v155, v91
    s_waitcnt lgkmcnt(4)
    v_mfma_f32_32x32x16_bf16 v[100:115], v[60:63], v[64:67], 0
    s_xor_b32 s76, s100, 5
    s_add_u32 m0, s74, 40960
    s_lshl_b32 s76, s76, 13
    buffer_load_dwordx4 v5, s[40:43], s76 offen sc1 lds
    v_fma_f32 v148, -v116, v92, v148
    v_fma_f32 v149, -v117, v93, v149
    v_fma_f32 v150, -v118, v94, v150
    v_fma_f32 v151, -v119, v95, v151
    v_fma_f32 v152, -v120, v96, v152
    v_fma_f32 v153, -v121, v97, v153
    v_mfma_f32_32x32x16_bf16 v[68:83], v[60:63], v[12:15], 0
    ds_read_b64_tr_b16 v[60:61], v10 offset:2048
    ds_read_b64_tr_b16 v[62:63], v10 offset:2304
    ds_read_b128 v[64:67], v36 offset:8192
    ds_read_b128 v[12:15], v36 offset:9216
    v_fma_f32 v154, -v122, v98, v154
    v_fma_f32 v155, -v123, v99, v155
    v_fma_f32 v116, v116, v84, v44
    v_fma_f32 v117, v117, v85, v45
    v_fma_f32 v118, v118, v86, v46
    v_fma_f32 v119, v119, v87, v47
    s_xor_b32 s76, s100, 6
    s_add_u32 m0, s74, 65536
    s_lshl_b32 s76, s76, 13
    buffer_load_dwordx4 v5, s[40:43], s76 offen sc1 lds
    v_fma_f32 v120, v120, v88, v48
    v_fma_f32 v121, v121, v89, v49
    v_fma_f32 v122, v122, v90, v50
    v_fma_f32 v123, v123, v91, v51
    v_cvt_pk_bf16_f32 v148, v148, v149
    v_cvt_pk_bf16_f32 v149, v150, v151
    s_waitcnt lgkmcnt(4)
    v_mfma_f32_32x32x16_bf16 v[100:115], v[16:19], v[164:167], v[100:115]
    s_xor_b32 s76, s100, 7
    s_add_u32 m0, s74, 73728
    s_lshl_b32 s76, s76, 13
    buffer_load_dwordx4 v5, s[40:43], s76 offen sc1 lds
    v_cvt_pk_bf16_f32 v150, v152, v153
    v_cvt_pk_bf16_f32 v151, v154, v155
    v_cvt_pk_bf16_f32 v116, v116, v117
    v_cvt_pk_bf16_f32 v117, v118, v119
    v_cvt_pk_bf16_f32 v118, v120, v121
    v_cvt_pk_bf16_f32 v119, v122, v123
    v_mfma_f32_32x32x16_bf16 v[68:83], v[16:19], v[20:23], v[68:83]
    ds_read_b64_tr_b16 v[16:17], v10 offset:3072
    ds_read_b64_tr_b16 v[18:19], v10 offset:3328
    ds_read_b128 v[164:167], v36 offset:10240
    ds_read_b128 v[20:23], v36 offset:11264
    v_mul_f32 v44, v156, v140
    v_mul_f32 v45, v157, v141
    v_mul_f32 v46, v158, v142
    v_mul_f32 v47, v159, v143
    v_mul_f32 v48, v160, v144
    v_mul_f32 v49, v161, v145
    v_mfma_f32_32x32x16_bf16 v[84:99], v[148:151], v[52:55], 0
    s_xor_b32 s83, s100, 6
    s_add_u32 m0, s75, 0
    s_lshl_b32 s83, s83, 17
    buffer_load_dwordx4 v6, s[68:71], s83 offen lds
    v_mul_f32 v50, v162, v146
    v_mul_f32 v51, v163, v147
    v_mul_f32 v156, v156, v132
    v_mul_f32 v157, v157, v133
    v_mul_f32 v158, v158, v134
    v_mul_f32 v159, v159, v135
    v_mfma_f32_32x32x16_bf16 v[84:99], v[116:119], v[28:31], v[84:99]
    v_mul_f32 v160, v160, v136
    v_mul_f32 v161, v161, v137
    v_mul_f32 v162, v162, v138
    v_mul_f32 v163, v163, v139
    v_fma_f32 v156, -v124, v140, v156
    v_fma_f32 v157, -v125, v141, v157
    s_waitcnt lgkmcnt(4)
    v_mfma_f32_32x32x16_bf16 v[100:115], v[60:63], v[64:67], v[100:115]
    v_fma_f32 v158, -v126, v142, v158
    v_fma_f32 v159, -v127, v143, v159
    v_fma_f32 v160, -v128, v144, v160
    v_fma_f32 v161, -v129, v145, v161
    v_fma_f32 v162, -v130, v146, v162
    v_fma_f32 v163, -v131, v147, v163
    v_mfma_f32_32x32x16_bf16 v[68:83], v[60:63], v[12:15], v[68:83]
    s_add_u32 m0, s75, 1024
    s_add_u32 s83, s83, 32768
    buffer_load_dwordx4 v6, s[68:71], s83 offen lds
    v_fma_f32 v124, v124, v132, v44
    v_fma_f32 v125, v125, v133, v45
    v_fma_f32 v126, v126, v134, v46
    v_fma_f32 v127, v127, v135, v47
    v_fma_f32 v128, v128, v136, v48
    v_fma_f32 v129, v129, v137, v49
    v_fma_f32 v130, v130, v138, v50
    v_fma_f32 v131, v131, v139, v51
    s_xor_b32 s83, s100, 7
    s_add_u32 m0, s75, 2048
    s_lshl_b32 s83, s83, 17
    buffer_load_dwordx4 v6, s[68:71], s83 offen lds
    v_cvt_pk_bf16_f32 v156, v156, v157
    v_cvt_pk_bf16_f32 v157, v158, v159
    v_cvt_pk_bf16_f32 v158, v160, v161
    v_cvt_pk_bf16_f32 v159, v162, v163
    v_cvt_pk_bf16_f32 v124, v124, v125
    v_cvt_pk_bf16_f32 v125, v126, v127
    v_cvt_pk_bf16_f32 v126, v128, v129
    v_cvt_pk_bf16_f32 v127, v130, v131
    v_mfma_f32_32x32x16_bf16 v[84:99], v[156:159], v[56:59], v[84:99]
    s_nop 0
    v_mfma_f32_32x32x16_bf16 v[84:99], v[124:127], v[32:35], v[84:99]
    s_waitcnt lgkmcnt(0)
    v_mfma_f32_32x32x16_bf16 v[100:115], v[16:19], v[164:167], v[100:115]
    s_waitcnt vmcnt(3)
    s_barrier
    ds_read_b64_tr_b16 v[60:61], v10 offset:4096
    ds_read_b64_tr_b16 v[62:63], v10 offset:4352
    ds_read_b128 v[64:67], v36 offset:16384
    ds_read_b128 v[12:15], v36 offset:17408
    s_add_u32 m0, s75, 3072
    s_add_u32 s83, s83, 32768
    buffer_load_dwordx4 v6, s[68:71], s83 offen lds
    v_mfma_f32_32x32x16_bf16 v[68:83], v[16:19], v[20:23], v[68:83]
    ds_read_b64_tr_b16 v[16:17], v10 offset:5120
    ds_read_b64_tr_b16 v[18:19], v10 offset:5376
    ds_read_b128 v[164:167], v36 offset:18432
    ds_read_b128 v[20:23], v36 offset:19456
    s_waitcnt lgkmcnt(4)
    v_mfma_f32_32x32x16_bf16 v[100:115], v[60:63], v[64:67], v[100:115]
    s_xor_b32 s83, s100, 8
    s_add_u32 m0, s75, 4096
    s_lshl_b32 s83, s83, 17
    buffer_load_dwordx4 v6, s[68:71], s83 offen lds
    v_cvt_pk_bf16_f32 v132, v84, v85
    v_cvt_pk_bf16_f32 v133, v86, v87
    v_cvt_pk_bf16_f32 v134, v88, v89
    v_cvt_pk_bf16_f32 v135, v90, v91
    v_cvt_pk_bf16_f32 v136, v92, v93
    v_cvt_pk_bf16_f32 v137, v94, v95
    v_cvt_pk_bf16_f32 v138, v96, v97
    v_cvt_pk_bf16_f32 v139, v98, v99
    v_mfma_f32_32x32x16_bf16 v[68:83], v[60:63], v[12:15], v[68:83]
    ds_read_b64_tr_b16 v[60:61], v10 offset:6144
    ds_read_b64_tr_b16 v[62:63], v10 offset:6400
    ds_read_b128 v[64:67], v36 offset:24576
    ds_read_b128 v[12:15], v36 offset:25600
    s_waitcnt lgkmcnt(4)
    v_mfma_f32_32x32x16_bf16 v[100:115], v[16:19], v[164:167], v[100:115]
    s_add_u32 m0, s75, 5120
    s_add_u32 s83, s83, 32768
    buffer_load_dwordx4 v6, s[68:71], s83 offen lds
    v_mfma_f32_32x32x16_bf16 v[68:83], v[16:19], v[20:23], v[68:83]
    ds_read_b64_tr_b16 v[16:17], v10 offset:7168
    ds_read_b64_tr_b16 v[18:19], v10 offset:7424
    ds_read_b128 v[164:167], v36 offset:26624
    ds_read_b128 v[20:23], v36 offset:27648
    s_waitcnt lgkmcnt(4)
    v_mfma_f32_32x32x16_bf16 v[100:115], v[60:63], v[64:67], v[100:115]
    s_xor_b32 s83, s100, 9
    s_add_u32 m0, s75, 6144
    s_lshl_b32 s83, s83, 17
    buffer_load_dwordx4 v6, s[68:71], s83 offen lds
    v_mfma_f32_32x32x16_bf16 v[68:83], v[60:63], v[12:15], v[68:83]
    ds_read_b64_tr_b16 v[60:61], v41 offset:0
    ds_read_b64_tr_b16 v[62:63], v41 offset:256
    ds_read_b128 v[64:67], v36 offset:32768
    ds_read_b128 v[12:15], v36 offset:33792
    s_waitcnt lgkmcnt(4)
    v_mfma_f32_32x32x16_bf16 v[100:115], v[16:19], v[164:167], v[100:115]
    s_add_u32 m0, s75, 7168
    s_add_u32 s83, s83, 32768
    buffer_load_dwordx4 v6, s[68:71], s83 offen lds
    v_mfma_f32_32x32x16_bf16 v[68:83], v[16:19], v[20:23], v[68:83]
    ds_read_b64_tr_b16 v[16:17], v41 offset:1024
    ds_read_b64_tr_b16 v[18:19], v41 offset:1280
    ds_read_b128 v[164:167], v36 offset:34816
    ds_read_b128 v[20:23], v36 offset:35840
    s_waitcnt lgkmcnt(4)
    v_mfma_f32_32x32x16_bf16 v[100:115], v[60:63], v[64:67], v[100:115]
    s_xor_b32 s83, s100, 10
    s_add_u32 m0, s87, 0
    s_lshl_b32 s83, s83, 17
    buffer_load_dwordx4 v6, s[68:71], s83 offen lds
    v_mfma_f32_32x32x16_bf16 v[68:83], v[60:63], v[12:15], v[68:83]
    ds_read_b64_tr_b16 v[60:61], v41 offset:2048
    ds_read_b64_tr_b16 v[62:63], v41 offset:2304
    ds_read_b128 v[64:67], v36 offset:40960
    ds_read_b128 v[12:15], v36 offset:41984
    s_waitcnt lgkmcnt(4)
    v_mfma_f32_32x32x16_bf16 v[100:115], v[16:19], v[164:167], v[100:115]
    s_add_u32 m0, s87, 1024
    s_add_u32 s83, s83, 32768
    buffer_load_dwordx4 v6, s[68:71], s83 offen lds
    v_mfma_f32_32x32x16_bf16 v[68:83], v[16:19], v[20:23], v[68:83]
    ds_read_b64_tr_b16 v[16:17], v41 offset:3072
    ds_read_b64_tr_b16 v[18:19], v41 offset:3328
    ds_read_b128 v[164:167], v36 offset:43008
    ds_read_b128 v[20:23], v36 offset:44032
    s_waitcnt lgkmcnt(4)
    v_mfma_f32_32x32x16_bf16 v[100:115], v[60:63], v[64:67], v[100:115]
    s_xor_b32 s83, s100, 11
    s_add_u32 m0, s87, 2048
    s_lshl_b32 s83, s83, 17
    buffer_load_dwordx4 v6, s[68:71], s83 offen lds
    v_mfma_f32_32x32x16_bf16 v[68:83], v[60:63], v[12:15], v[68:83]
    s_waitcnt lgkmcnt(0)
    v_mfma_f32_32x32x16_bf16 v[100:115], v[16:19], v[164:167], v[100:115]
    s_waitcnt vmcnt(10)
    s_barrier
    ds_read_b64_tr_b16 v[60:61], v10 offset:0
    ds_read_b64_tr_b16 v[62:63], v10 offset:256
    ds_read_b128 v[64:67], v42 offset:0
    ds_read_b128 v[12:15], v42 offset:1024
    s_xor_b32 s76, s100, 12
    s_add_u32 m0, s74, 32768
    s_lshl_b32 s76, s76, 13
    buffer_load_dwordx4 v5, s[40:43], s76 offen sc1 lds
    s_add_u32 m0, s87, 3072
    s_add_u32 s83, s83, 32768
    buffer_load_dwordx4 v6, s[68:71], s83 offen lds
    v_mfma_f32_32x32x16_bf16 v[68:83], v[16:19], v[20:23], v[68:83]
    s_waitcnt vmcnt(11)
    ds_read_b64_tr_b16 v[16:17], v10 offset:1024
    ds_read_b64_tr_b16 v[18:19], v10 offset:1280
    ds_read_b128 v[164:167], v42 offset:2048
    ds_read_b128 v[20:23], v42 offset:3072
    s_waitcnt lgkmcnt(4)
    v_mfma_f32_32x32x16_bf16 v[100:115], v[60:63], v[64:67], v[100:115]
    s_xor_b32 s76, s100, 13
    s_add_u32 m0, s74, 40960
    s_lshl_b32 s76, s76, 13
    buffer_load_dwordx4 v5, s[40:43], s76 offen sc1 lds
    s_xor_b32 s83, s100, 12
    s_add_u32 m0, s75, 0
    s_lshl_b32 s83, s83, 17
    buffer_load_dwordx4 v6, s[68:71], s83 offen lds
    v_mfma_f32_32x32x16_bf16 v[68:83], v[60:63], v[12:15], v[68:83]
    s_waitcnt vmcnt(12)
    ds_read_b64_tr_b16 v[60:61], v10 offset:2048
    ds_read_b64_tr_b16 v[62:63], v10 offset:2304
    ds_read_b128 v[64:67], v42 offset:8192
    ds_read_b128 v[12:15], v42 offset:9216
    s_waitcnt lgkmcnt(4)
    v_mfma_f32_32x32x16_bf16 v[100:115], v[16:19], v[164:167], v[100:115]
    s_add_u32 m0, s75, 1024
    s_add_u32 s83, s83, 32768
    buffer_load_dwordx4 v6, s[68:71], s83 offen lds
    v_mfma_f32_32x32x16_bf16 v[68:83], v[16:19], v[20:23], v[68:83]
    s_waitcnt vmcnt(12)
    ds_read_b64_tr_b16 v[16:17], v10 offset:3072
    ds_read_b64_tr_b16 v[18:19], v10 offset:3328
    ds_read_b128 v[164:167], v42 offset:10240
    ds_read_b128 v[20:23], v42 offset:11264
    s_waitcnt lgkmcnt(4)
    v_mfma_f32_32x32x16_bf16 v[100:115], v[60:63], v[64:67], v[100:115]
    s_xor_b32 s83, s100, 13
    s_add_u32 m0, s75, 2048
    s_lshl_b32 s83, s83, 17
    buffer_load_dwordx4 v6, s[68:71], s83 offen lds
    v_mfma_f32_32x32x16_bf16 v[68:83], v[60:63], v[12:15], v[68:83]
    s_waitcnt vmcnt(12)
    ds_read_b64_tr_b16 v[60:61], v10 offset:4096
    ds_read_b64_tr_b16 v[62:63], v10 offset:4352
    ds_read_b128 v[64:67], v36 offset:0
    ds_read_b128 v[12:15], v36 offset:1024
    s_waitcnt lgkmcnt(4)
    v_mfma_f32_32x32x16_bf16 v[100:115], v[16:19], v[164:167], v[100:115]
    s_add_u32 m0, s75, 3072
    s_add_u32 s83, s83, 32768
    buffer_load_dwordx4 v6, s[68:71], s83 offen lds
    v_mfma_f32_32x32x16_bf16 v[68:83], v[16:19], v[20:23], v[68:83]
    s_waitcnt vmcnt(12)
    ds_read_b64_tr_b16 v[16:17], v10 offset:5120
    ds_read_b64_tr_b16 v[18:19], v10 offset:5376
    ds_read_b128 v[164:167], v36 offset:2048
    ds_read_b128 v[20:23], v36 offset:3072
    s_waitcnt lgkmcnt(4)
    v_mfma_f32_32x32x16_bf16 v[100:115], v[60:63], v[64:67], v[100:115]
    s_xor_b32 s83, s100, 14
    s_add_u32 m0, s75, 4096
    s_lshl_b32 s83, s83, 17
    buffer_load_dwordx4 v6, s[68:71], s83 offen lds
    v_mfma_f32_32x32x16_bf16 v[68:83], v[60:63], v[12:15], v[68:83]
    s_waitcnt vmcnt(12)
    ds_read_b64_tr_b16 v[60:61], v10 offset:6144
    ds_read_b64_tr_b16 v[62:63], v10 offset:6400
    ds_read_b128 v[64:67], v36 offset:8192
    ds_read_b128 v[12:15], v36 offset:9216
    s_waitcnt lgkmcnt(4)
    v_mfma_f32_32x32x16_bf16 v[100:115], v[16:19], v[164:167], v[100:115]
    s_add_u32 m0, s75, 5120
    s_add_u32 s83, s83, 32768
    buffer_load_dwordx4 v6, s[68:71], s83 offen lds
    v_mfma_f32_32x32x16_bf16 v[68:83], v[16:19], v[20:23], v[68:83]
    s_waitcnt vmcnt(12)
    ds_read_b64_tr_b16 v[16:17], v10 offset:7168
    ds_read_b64_tr_b16 v[18:19], v10 offset:7424
    ds_read_b128 v[164:167], v36 offset:10240
    ds_read_b128 v[20:23], v36 offset:11264
    s_waitcnt lgkmcnt(4)
    v_mfma_f32_32x32x16_bf16 v[100:115], v[60:63], v[64:67], v[100:115]
    s_xor_b32 s83, s100, 15
    s_add_u32 m0, s75, 6144
    s_lshl_b32 s83, s83, 17
    buffer_load_dwordx4 v6, s[68:71], s83 offen lds
    v_mfma_f32_32x32x16_bf16 v[68:83], v[60:63], v[12:15], v[68:83]
    s_waitcnt lgkmcnt(0)
    v_mfma_f32_32x32x16_bf16 v[100:115], v[16:19], v[164:167], v[100:115]
    s_waitcnt vmcnt(7)
    s_barrier
    ds_read_b64_tr_b16 v[60:61], v41 offset:0
    ds_read_b64_tr_b16 v[62:63], v41 offset:256
    ds_read_b128 v[64:67], v36 offset:16384
    ds_read_b128 v[12:15], v36 offset:17408
    s_add_u32 m0, s75, 7168
    s_add_u32 s83, s83, 32768
    buffer_load_dwordx4 v6, s[68:71], s83 offen lds
    v_mfma_f32_32x32x16_bf16 v[68:83], v[16:19], v[20:23], v[68:83]
    ds_read_b64_tr_b16 v[16:17], v41 offset:1024
    ds_read_b64_tr_b16 v[18:19], v41 offset:1280
    ds_read_b128 v[164:167], v36 offset:18432
    ds_read_b128 v[20:23], v36 offset:19456
    s_waitcnt lgkmcnt(4)
    v_mfma_f32_32x32x16_bf16 v[100:115], v[60:63], v[64:67], v[100:115]
    v_mfma_f32_32x32x16_bf16 v[68:83], v[60:63], v[12:15], v[68:83]
    ds_read_b64_tr_b16 v[60:61], v41 offset:2048
    ds_read_b64_tr_b16 v[62:63], v41 offset:2304
    ds_read_b128 v[64:67], v36 offset:24576
    ds_read_b128 v[12:15], v36 offset:25600
    s_waitcnt lgkmcnt(4)
    v_mfma_f32_32x32x16_bf16 v[100:115], v[16:19], v[164:167], v[100:115]
    v_mfma_f32_32x32x16_bf16 v[68:83], v[16:19], v[20:23], v[68:83]
    ds_read_b64_tr_b16 v[16:17], v41 offset:3072
    ds_read_b64_tr_b16 v[18:19], v41 offset:3328
    ds_read_b128 v[164:167], v36 offset:26624
    ds_read_b128 v[20:23], v36 offset:27648
    s_waitcnt lgkmcnt(4)
    v_mfma_f32_32x32x16_bf16 v[100:115], v[60:63], v[64:67], v[100:115]
    v_bfe_u32 v2, v39, 7, 1
    v_bfe_u32 v3, v39, 9, 1
    v_lshl_or_b32 v2, v3, 1, v2
    v_lshlrev_b32 v2, 4, v2
    v_xor_b32 v39, v39, v2
    v_add_u32 v39, s87, v39
    v_xor_b32 v26, 32, v39
    v_mfma_f32_32x32x16_bf16 v[68:83], v[60:63], v[12:15], v[68:83]
    s_waitcnt vmcnt(7)
    ds_read_b64_tr_b16 v[60:61], v10 offset:0
    ds_read_b64_tr_b16 v[62:63], v10 offset:256
    ds_read_b128 v[64:67], v36 offset:32768
    ds_read_b128 v[12:15], v36 offset:33792
    s_waitcnt lgkmcnt(4)
    v_mfma_f32_32x32x16_bf16 v[100:115], v[16:19], v[164:167], v[100:115]
    v_bfe_u32 v2, v0, 3, 1
    v_bfe_u32 v3, v0, 5, 1
    v_lshl_or_b32 v2, v3, 1, v2
    v_lshlrev_b32 v2, 4, v2
    v_xor_b32 v27, v1, v2
    v_add_u32 v43, s87, v1
    v_mfma_f32_32x32x16_bf16 v[68:83], v[16:19], v[20:23], v[68:83]
    s_waitcnt vmcnt(6)
    ds_read_b64_tr_b16 v[16:17], v10 offset:1024
    ds_read_b64_tr_b16 v[18:19], v10 offset:1280
    ds_read_b128 v[164:167], v36 offset:34816
    ds_read_b128 v[20:23], v36 offset:35840
    s_waitcnt lgkmcnt(4)
    v_mfma_f32_32x32x16_bf16 v[100:115], v[60:63], v[64:67], v[100:115]
    ds_write_b128 v39, v[132:135]
    ds_write_b128 v26, v[136:139]
    v_mfma_f32_32x32x16_bf16 v[68:83], v[60:63], v[12:15], v[68:83]
    s_waitcnt vmcnt(5)
    ds_read_b64_tr_b16 v[60:61], v10 offset:2048
    ds_read_b64_tr_b16 v[62:63], v10 offset:2304
    ds_read_b128 v[64:67], v36 offset:40960
    ds_read_b128 v[12:15], v36 offset:41984
    s_waitcnt lgkmcnt(4)
    v_mfma_f32_32x32x16_bf16 v[100:115], v[16:19], v[164:167], v[100:115]
    ds_read_b128 v[132:135], v43
    ds_read_b128 v[136:139], v43 offset:1024
    v_mfma_f32_32x32x16_bf16 v[68:83], v[16:19], v[20:23], v[68:83]
    s_waitcnt vmcnt(4)
    ds_read_b64_tr_b16 v[16:17], v10 offset:3072
    ds_read_b64_tr_b16 v[18:19], v10 offset:3328
    ds_read_b128 v[164:167], v36 offset:43008
    ds_read_b128 v[20:23], v36 offset:44032
    s_waitcnt lgkmcnt(4)
    v_mfma_f32_32x32x16_bf16 v[100:115], v[60:63], v[64:67], v[100:115]
    buffer_store_dwordx4 v[132:135], v27, s[64:67], s80 offen nt
    buffer_store_dwordx4 v[136:139], v27, s[64:67], s80 offen offset:1024 nt
    v_add_u32 v37, s87, v1
    s_lshl_b32 s8, s73, 16
    s_sub_u32 s8, 32768, s8
    v_add_u32 v38, s8, v37
    v_mfma_f32_32x32x16_bf16 v[68:83], v[60:63], v[12:15], v[68:83]
    s_waitcnt lgkmcnt(0)
    v_mfma_f32_32x32x16_bf16 v[100:115], v[16:19], v[164:167], v[100:115]
    s_waitcnt vmcnt(5)
    s_barrier
    ds_read_b64_tr_b16 v[60:61], v10 offset:4096
    ds_read_b64_tr_b16 v[62:63], v10 offset:4352
    ds_read_b128 v[64:67], v42 offset:0
    ds_read_b128 v[12:15], v42 offset:1024
    v_and_b32 v2, 31, v0
    v_lshlrev_b32 v2, 6, v2
    v_lshl_add_u32 v2, v4, 4, v2
    v_bfe_u32 v3, v0, 1, 2
    v_lshlrev_b32 v3, 4, v3
    v_xor_b32 v2, v2, v3
    v_add_u32 v39, s75, v2
    v_xor_b32 v26, 32, v39
    v_add_u32 v43, s75, v1
    v_bfe_u32 v3, v0, 3, 2
    v_xor_b32 v3, v3, v0
    v_and_b32 v3, 3, v3
    v_lshlrev_b32 v3, 4, v3
    v_lshrrev_b32 v40, 2, v0
    v_lshl_add_u32 v40, v40, 12, v3
    v_and_b32 v2, 31, v0
    v_lshlrev_b32 v2, 12, v2
    v_lshl_add_u32 v2, v4, 4, v2
    s_lshl_b32 s8, s4, 1
    s_add_u32 s8, s8, s73
    s_lshl_b32 s8, s8, 17
    s_lshl_b32 s9, s5, 8
    s_add_u32 s8, s8, s9
    s_lshl_b32 s9, s72, 6
    s_add_u32 s8, s8, s9
    s_add_u32 s8, s8, 2048
    v_mfma_f32_32x32x16_bf16 v[68:83], v[16:19], v[20:23], v[68:83]
    s_waitcnt vmcnt(4)
    ds_read_b64_tr_b16 v[16:17], v10 offset:5120
    ds_read_b64_tr_b16 v[18:19], v10 offset:5376
    ds_read_b128 v[164:167], v42 offset:2048
    ds_read_b128 v[20:23], v42 offset:3072
    s_waitcnt lgkmcnt(4)
    v_mfma_f32_32x32x16_bf16 v[100:115], v[60:63], v[64:67], v[100:115]
    v_mfma_f32_32x32x16_bf16 v[68:83], v[60:63], v[12:15], v[68:83]
    s_waitcnt vmcnt(3)
    ds_read_b64_tr_b16 v[60:61], v10 offset:6144
    ds_read_b64_tr_b16 v[62:63], v10 offset:6400
    ds_read_b128 v[64:67], v42 offset:8192
    ds_read_b128 v[12:15], v42 offset:9216
    s_waitcnt lgkmcnt(4)
    v_mfma_f32_32x32x16_bf16 v[100:115], v[16:19], v[164:167], v[100:115]
    v_mfma_f32_32x32x16_bf16 v[68:83], v[16:19], v[20:23], v[68:83]
    s_waitcnt vmcnt(2)
    ds_read_b64_tr_b16 v[116:117], v10 offset:7168
    ds_read_b64_tr_b16 v[118:119], v10 offset:7424
    ds_read_b128 v[120:123], v42 offset:10240
    ds_read_b128 v[124:127], v42 offset:11264
    s_cmp_eq_u32 s73, 0
    s_cbranch_scc0 L_e1
    s_waitcnt lgkmcnt(4)
    v_mfma_f32_32x32x16_bf16 v[68:83], v[60:63], v[12:15], v[68:83]
    s_waitcnt lgkmcnt(0)
    v_mfma_f32_32x32x16_bf16 v[68:83], v[116:119], v[124:127], v[68:83]
    v_mfma_f32_32x32x16_bf16 v[100:115], v[60:63], v[64:67], v[100:115]
    v_mfma_f32_32x32x16_bf16 v[100:115], v[116:119], v[120:123], v[100:115]
    s_nop 9
    ds_write_b128 v37, v[68:71] offset:0
    ds_write_b128 v37, v[72:75] offset:1024
    ds_write_b128 v37, v[76:79] offset:2048
    ds_write_b128 v37, v[80:83] offset:3072
    s_waitcnt lgkmcnt(0)
    s_barrier
    ds_read_b128 v[68:71], v38 offset:0
    ds_read_b128 v[72:75], v38 offset:1024
    ds_read_b128 v[76:79], v38 offset:2048
    ds_read_b128 v[80:83], v38 offset:3072
    s_waitcnt lgkmcnt(3)
    v_pk_add_f32 v[100:101], v[100:101], v[68:69]
    v_pk_add_f32 v[102:103], v[102:103], v[70:71]
    v_cvt_pk_bf16_f32 v148, v100, v101
    v_cvt_pk_bf16_f32 v149, v102, v103
    s_waitcnt lgkmcnt(2)
    v_pk_add_f32 v[104:105], v[104:105], v[72:73]
    v_pk_add_f32 v[106:107], v[106:107], v[74:75]
    v_cvt_pk_bf16_f32 v150, v104, v105
    v_cvt_pk_bf16_f32 v151, v106, v107
    ds_write_b128 v39, v[148:151]
    s_waitcnt lgkmcnt(1)
    v_pk_add_f32 v[108:109], v[108:109], v[76:77]
    v_pk_add_f32 v[110:111], v[110:111], v[78:79]
    v_cvt_pk_bf16_f32 v152, v108, v109
    v_cvt_pk_bf16_f32 v153, v110, v111
    s_waitcnt lgkmcnt(0)
    v_pk_add_f32 v[112:113], v[112:113], v[80:81]
    v_pk_add_f32 v[114:115], v[114:115], v[82:83]
    v_cvt_pk_bf16_f32 v154, v112, v113
    v_cvt_pk_bf16_f32 v155, v114, v115
    ds_write_b128 v26, v[152:155]
    s_add_u32 s9, s8, 65536
    s_waitcnt lgkmcnt(0)
    ds_read_b128 v[148:151], v43
    ds_read_b128 v[152:155], v43 offset:1024
    s_waitcnt lgkmcnt(1)
    buffer_store_dwordx4 v[148:151], v40, s[64:67], s8 offen nt
    s_waitcnt lgkmcnt(0)
    buffer_store_dwordx4 v[152:155], v40, s[64:67], s9 offen nt
    s_endpgm
L_e1:
    s_waitcnt lgkmcnt(4)
    v_mfma_f32_32x32x16_bf16 v[100:115], v[60:63], v[64:67], v[100:115]
    s_waitcnt lgkmcnt(0)
    v_mfma_f32_32x32x16_bf16 v[100:115], v[116:119], v[120:123], v[100:115]
    v_mfma_f32_32x32x16_bf16 v[68:83], v[60:63], v[12:15], v[68:83]
    v_mfma_f32_32x32x16_bf16 v[68:83], v[116:119], v[124:127], v[68:83]
    s_nop 9
    ds_write_b128 v37, v[100:103] offset:0
    ds_write_b128 v37, v[104:107] offset:1024
    ds_write_b128 v37, v[108:111] offset:2048
    ds_write_b128 v37, v[112:115] offset:3072
    s_waitcnt lgkmcnt(0)
    s_barrier
    ds_read_b128 v[100:103], v38 offset:0
    ds_read_b128 v[104:107], v38 offset:1024
    ds_read_b128 v[108:111], v38 offset:2048
    ds_read_b128 v[112:115], v38 offset:3072
    s_waitcnt lgkmcnt(3)
    v_pk_add_f32 v[68:69], v[68:69], v[100:101]
    v_pk_add_f32 v[70:71], v[70:71], v[102:103]
    v_cvt_pk_bf16_f32 v148, v68, v69
    v_cvt_pk_bf16_f32 v149, v70, v71
    s_waitcnt lgkmcnt(2)
    v_pk_add_f32 v[72:73], v[72:73], v[104:105]
    v_pk_add_f32 v[74:75], v[74:75], v[106:107]
    v_cvt_pk_bf16_f32 v150, v72, v73
    v_cvt_pk_bf16_f32 v151, v74, v75
    ds_write_b128 v39, v[148:151]
    s_waitcnt lgkmcnt(1)
    v_pk_add_f32 v[76:77], v[76:77], v[108:109]
    v_pk_add_f32 v[78:79], v[78:79], v[110:111]
    v_cvt_pk_bf16_f32 v152, v76, v77
    v_cvt_pk_bf16_f32 v153, v78, v79
    s_waitcnt lgkmcnt(0)
    v_pk_add_f32 v[80:81], v[80:81], v[112:113]
    v_pk_add_f32 v[82:83], v[82:83], v[114:115]
    v_cvt_pk_bf16_f32 v154, v80, v81
    v_cvt_pk_bf16_f32 v155, v82, v83
    ds_write_b128 v26, v[152:155]
    s_add_u32 s9, s8, 65536
    s_waitcnt lgkmcnt(0)
    ds_read_b128 v[148:151], v43
    ds_read_b128 v[152:155], v43 offset:1024
    s_waitcnt lgkmcnt(1)
    buffer_store_dwordx4 v[148:151], v40, s[64:67], s8 offen nt
    s_waitcnt lgkmcnt(0)
    buffer_store_dwordx4 v[152:155], v40, s[64:67], s9 offen nt
L_e2:
L_end:
    s_endpgm
L_pause:
    s_mov_b32 s98, 7
L_attnF:
    s_waitcnt lgkmcnt(2)
    v_mfma_f32_32x32x16_bf16 v[116:131], v[36:39], v[12:15], v[52:67]
    ds_read_b128 v[84:87], v23 offset:0
    ds_read_b64_tr_b16 v[88:89], v20 offset:0
    ds_read_b64_tr_b16 v[90:91], v20 offset:512
    ds_read_b64_tr_b16 v[92:93], v22 offset:0
    ds_read_b64_tr_b16 v[94:95], v22 offset:512
    v_exp_f32 v100, v100
    v_exp_f32 v101, v101
    v_mfma_f32_32x32x16_bf16 v[116:131], v[40:43], v[16:19], v[116:131]
    s_setprio 1
    ds_read_b128 v[36:39], v26 offset:8192
    ds_read_b128 v[40:43], v26 offset:9216
    v_exp_f32 v102, v102
    v_exp_f32 v103, v103
    v_exp_f32 v104, v104
    s_waitcnt lgkmcnt(7)
    v_smfmac_f32_32x32x32_bf16 v[148:163], v[44:47], v[132:139], v8
    v_exp_f32 v105, v105
    v_exp_f32 v106, v106
    v_exp_f32 v107, v107
    v_smfmac_f32_16x16x64_bf16 v[32:35], v[28:31], v[132:139], v8
    v_exp_f32 v108, v108
    v_exp_f32 v109, v109
    s_waitcnt lgkmcnt(2)
    v_mfma_f32_16x16x32_bf16 v[68:71], v[88:91], v[84:87], v[68:71]
    v_exp_f32 v110, v110
    v_exp_f32 v111, v111
    v_mfma_f32_16x16x32_bf16 v[72:75], v[92:95], v[84:87], v[72:75]
    v_smfmac_f32_16x16x64_bf16 v[32:35], v[28:31], v[140:147], v8
    v_exp_f32 v112, v112
    v_smfmac_f32_32x32x32_bf16 v[148:163], v[48:51], v[140:147], v8
    ds_read_b128 v[44:47], v26 offset:2048
    ds_read_b128 v[48:51], v26 offset:3072
    v_exp_f32 v113, v113
    v_exp_f32 v114, v114
    v_exp_f32 v115, v115
    s_waitcnt lgkmcnt(2)
    v_mfma_f32_32x32x16_bf16 v[84:99], v[36:39], v[12:15], v[52:67]
    ds_read_b128 v[132:135], v23 offset:1024
    ds_read_b64_tr_b16 v[136:137], v20 offset:4096
    ds_read_b64_tr_b16 v[138:139], v20 offset:4608
    ds_read_b64_tr_b16 v[140:141], v22 offset:4096
    ds_read_b64_tr_b16 v[142:143], v22 offset:4608
    v_exp_f32 v116, v116
    v_exp_f32 v117, v117
    v_mfma_f32_32x32x16_bf16 v[84:99], v[40:43], v[16:19], v[84:99]
    s_setprio 0
    ds_read_b128 v[36:39], v26 offset:12288
    ds_read_b128 v[40:43], v26 offset:13312
    v_exp_f32 v118, v118
    v_exp_f32 v119, v119
    v_exp_f32 v120, v120
    s_waitcnt lgkmcnt(7)
    v_smfmac_f32_32x32x32_bf16 v[148:163], v[44:47], v[100:107], v8
    v_exp_f32 v121, v121
    v_exp_f32 v122, v122
    v_exp_f32 v123, v123
    v_smfmac_f32_16x16x64_bf16 v[32:35], v[28:31], v[100:107], v8
    v_exp_f32 v124, v124
    v_exp_f32 v125, v125
    s_waitcnt lgkmcnt(2)
    v_mfma_f32_16x16x32_bf16 v[76:79], v[136:139], v[132:135], v[76:79]
    v_exp_f32 v126, v126
    v_exp_f32 v127, v127
    v_mfma_f32_16x16x32_bf16 v[80:83], v[140:143], v[132:135], v[80:83]
    v_smfmac_f32_16x16x64_bf16 v[32:35], v[28:31], v[108:115], v8
    v_exp_f32 v128, v128
    v_smfmac_f32_32x32x32_bf16 v[148:163], v[48:51], v[108:115], v8
    ds_read_b128 v[44:47], v26 offset:6144
    ds_read_b128 v[48:51], v26 offset:7168
    v_exp_f32 v129, v129
    v_exp_f32 v130, v130
    v_exp_f32 v131, v131
    s_waitcnt lgkmcnt(2)
    v_mfma_f32_32x32x16_bf16 v[132:147], v[36:39], v[12:15], v[52:67]
    ds_read_b128 v[100:103], v23 offset:16384
    ds_read_b64_tr_b16 v[104:105], v20 offset:16384
    ds_read_b64_tr_b16 v[106:107], v20 offset:16896
    ds_read_b64_tr_b16 v[108:109], v22 offset:16384
    ds_read_b64_tr_b16 v[110:111], v22 offset:16896
    v_exp_f32 v84, v84
    v_exp_f32 v85, v85
    v_mfma_f32_32x32x16_bf16 v[132:147], v[40:43], v[16:19], v[132:147]
    s_barrier
    s_setprio 3
    ds_read_b128 v[36:39], v27 offset:0
    ds_read_b128 v[40:43], v27 offset:1024
    v_exp_f32 v86, v86
    v_exp_f32 v87, v87
    v_exp_f32 v88, v88
    s_waitcnt lgkmcnt(7)
    v_smfmac_f32_32x32x32_bf16 v[148:163], v[44:47], v[116:123], v8
    v_exp_f32 v89, v89
    v_exp_f32 v90, v90
    v_exp_f32 v91, v91
    v_smfmac_f32_16x16x64_bf16 v[32:35], v[28:31], v[116:123], v8
    v_exp_f32 v92, v92
    v_exp_f32 v93, v93
    s_waitcnt lgkmcnt(2)
    v_mfma_f32_16x16x32_bf16 v[68:71], v[104:107], v[100:103], v[68:71]
    v_exp_f32 v94, v94
    v_exp_f32 v95, v95
    v_mfma_f32_16x16x32_bf16 v[72:75], v[108:111], v[100:103], v[72:75]
    v_smfmac_f32_16x16x64_bf16 v[32:35], v[28:31], v[124:131], v8
    v_exp_f32 v96, v96
    v_smfmac_f32_32x32x32_bf16 v[148:163], v[48:51], v[124:131], v8
    ds_read_b128 v[44:47], v26 offset:10240
    ds_read_b128 v[48:51], v26 offset:11264
    v_exp_f32 v97, v97
    v_exp_f32 v98, v98
    v_exp_f32 v99, v99
    s_waitcnt lgkmcnt(2)
    v_mfma_f32_32x32x16_bf16 v[100:115], v[36:39], v[12:15], v[52:67]
    ds_read_b128 v[116:119], v23 offset:17408
    ds_read_b64_tr_b16 v[120:121], v20 offset:20480
    ds_read_b64_tr_b16 v[122:123], v20 offset:20992
    ds_read_b64_tr_b16 v[124:125], v22 offset:20480
    ds_read_b64_tr_b16 v[126:127], v22 offset:20992
    v_exp_f32 v132, v132
    v_exp_f32 v133, v133
    v_mfma_f32_32x32x16_bf16 v[100:115], v[40:43], v[16:19], v[100:115]
    s_setprio 2
    ds_read_b128 v[36:39], v27 offset:4096
    ds_read_b128 v[40:43], v27 offset:5120
    v_exp_f32 v134, v134
    v_exp_f32 v135, v135
    v_exp_f32 v136, v136
    s_waitcnt lgkmcnt(7)
    v_smfmac_f32_32x32x32_bf16 v[148:163], v[44:47], v[84:91], v8
    v_exp_f32 v137, v137
    v_exp_f32 v138, v138
    v_exp_f32 v139, v139
    v_smfmac_f32_16x16x64_bf16 v[32:35], v[28:31], v[84:91], v8
    v_exp_f32 v140, v140
    v_exp_f32 v141, v141
    s_waitcnt lgkmcnt(2)
    v_mfma_f32_16x16x32_bf16 v[76:79], v[120:123], v[116:119], v[76:79]
    v_exp_f32 v142, v142
    v_exp_f32 v143, v143
    v_mfma_f32_16x16x32_bf16 v[80:83], v[124:127], v[116:119], v[80:83]
    v_add_u32 v20, 32768, v20
    v_add_u32 v22, 32768, v22
    v_add_u32 v23, 32768, v23
    v_smfmac_f32_16x16x64_bf16 v[32:35], v[28:31], v[92:99], v8
    v_exp_f32 v144, v144
    v_smfmac_f32_32x32x32_bf16 v[148:163], v[48:51], v[92:99], v8
    ds_read_b128 v[44:47], v26 offset:14336
    ds_read_b128 v[48:51], v26 offset:15360
    v_mov_b32 v26, v27
    s_add_u32 s78, s78, 16384
    s_cmp_eq_u32 s78, 49152
    s_cselect_b32 s78, 0, s78
    s_add_u32 s77, s77, 1
    v_add_u32 v27, s78, v1
    s_cmp_lg_u32 s77, s98
    v_exp_f32 v145, v145
    v_exp_f32 v146, v146
    v_exp_f32 v147, v147
    s_cbranch_scc1 L_attnF
    s_mov_b32 s98, 16
    s_mul_i32 s8, s79, 0x80008000
    v_add_f32 v84, v68, v76
    v_add_f32 v85, v69, v77
    v_add_f32 v86, v70, v78
    v_add_f32 v87, v71, v79
    v_add_f32 v88, v72, v80
    v_add_f32 v89, v73, v81
    v_add_f32 v90, v74, v82
    v_add_f32 v91, v75, v83
    v_sub_f32 v92, v68, v76
    v_sub_f32 v93, v69, v77
    v_sub_f32 v94, v70, v78
    v_sub_f32 v95, v71, v79
    v_sub_f32 v96, v72, v80
    v_sub_f32 v97, v73, v81
    v_sub_f32 v98, v74, v82
    v_sub_f32 v99, v75, v83
    v_cvt_pk_bf16_f32 v84, v84, v85
    v_cvt_pk_bf16_f32 v85, v86, v87
    v_cvt_pk_bf16_f32 v86, v88, v89
    v_cvt_pk_bf16_f32 v87, v90, v91
    v_cvt_pk_bf16_f32 v88, v92, v93
    v_cvt_pk_bf16_f32 v89, v94, v95
    v_cvt_pk_bf16_f32 v90, v96, v97
    v_cvt_pk_bf16_f32 v91, v98, v99
    v_xor_b32 v88, s8, v88
    v_xor_b32 v89, s8, v89
    v_xor_b32 v90, s8, v90
    v_xor_b32 v91, s8, v91
    ds_write_b64 v11, v[84:85]
    ds_write_b64 v25, v[86:87]
    ds_write_b64 v11, v[88:89] offset:8192
    ds_write_b64 v25, v[90:91] offset:8192
    s_waitcnt lgkmcnt(0)
    s_branch L_attn
L_fallback:
    s_add_u32 s40, s36, 0
    s_addc_u32 s41, s37, 0
    s_mov_b32 s42, 262144
    s_mov_b32 s43, 0x20000
    s_mov_b32 s8, 0
    v_mov_b32 v2, 0xff800000
L_fb1:
    buffer_load_dwordx4 v[116:119], v1, s[40:43], s8 offen sc1
    buffer_load_dwordx4 v[120:123], v1, s[40:43], s8 offen offset:1024 sc1
    s_waitcnt vmcnt(0)
    v_mfma_f32_32x32x16_bf16 v[84:99], v[116:119], v[12:15], 0
    v_mfma_f32_32x32x16_bf16 v[84:99], v[120:123], v[16:19], v[84:99]
    s_nop 11
    v_max3_f32 v2, v2, v84, v85
    v_max3_f32 v2, v2, v86, v87
    v_max3_f32 v2, v2, v88, v89
    v_max3_f32 v2, v2, v90, v91
    v_max3_f32 v2, v2, v92, v93
    v_max3_f32 v2, v2, v94, v95
    v_max3_f32 v2, v2, v96, v97
    v_max3_f32 v2, v2, v98, v99
    s_add_u32 s8, s8, 4096
    s_cmp_lt_u32 s8, 262144
    s_cbranch_scc1 L_fb1
    v_mov_b32 v3, v2
    s_nop 1
    v_permlane32_swap_b32 v2, v3
    v_max_f32 v2, v2, v3
    v_sub_f32 v2, 0, v2
    s_mov_b32 s8, 0
    v_mov_b32 v52, v2
    v_mov_b32 v148, 0
    v_mov_b32 v53, v2
    v_mov_b32 v149, 0
    v_mov_b32 v54, v2
    v_mov_b32 v150, 0
    v_mov_b32 v55, v2
    v_mov_b32 v151, 0
    v_mov_b32 v56, v2
    v_mov_b32 v152, 0
    v_mov_b32 v57, v2
    v_mov_b32 v153, 0
    v_mov_b32 v58, v2
    v_mov_b32 v154, 0
    v_mov_b32 v59, v2
    v_mov_b32 v155, 0
    v_mov_b32 v60, v2
    v_mov_b32 v156, 0
    v_mov_b32 v61, v2
    v_mov_b32 v157, 0
    v_mov_b32 v62, v2
    v_mov_b32 v158, 0
    v_mov_b32 v63, v2
    v_mov_b32 v159, 0
    v_mov_b32 v64, v2
    v_mov_b32 v160, 0
    v_mov_b32 v65, v2
    v_mov_b32 v161, 0
    v_mov_b32 v66, v2
    v_mov_b32 v162, 0
    v_mov_b32 v67, v2
    v_mov_b32 v163, 0
    v_mov_b32 v32, 0
    v_mov_b32 v33, 0
    v_mov_b32 v34, 0
    v_mov_b32 v35, 0
L_fb2:
    buffer_load_dwordx4 v[116:119], v1, s[40:43], s8 offen offset:0 sc1
    buffer_load_dwordx4 v[120:123], v1, s[40:43], s8 offen offset:1024 sc1
    buffer_load_dwordx4 v[124:127], v1, s[40:43], s8 offen offset:2048 sc1
    buffer_load_dwordx4 v[128:131], v1, s[40:43], s8 offen offset:3072 sc1
    s_waitcnt vmcnt(0)
    v_mfma_f32_32x32x16_bf16 v[84:99], v[116:119], v[12:15], v[52:67]
    v_mfma_f32_32x32x16_bf16 v[84:99], v[120:123], v[16:19], v[84:99]
    s_nop 11
    v_exp_f32 v84, v84
    v_exp_f32 v85, v85
    v_exp_f32 v86, v86
    v_exp_f32 v87, v87
    v_exp_f32 v88, v88
    v_exp_f32 v89, v89
    v_exp_f32 v90, v90
    v_exp_f32 v91, v91
    v_exp_f32 v92, v92
    v_exp_f32 v93, v93
    v_exp_f32 v94, v94
    v_exp_f32 v95, v95
    v_exp_f32 v96, v96
    v_exp_f32 v97, v97
    v_exp_f32 v98, v98
    v_exp_f32 v99, v99
    v_smfmac_f32_32x32x32_bf16 v[148:163], v[124:127], v[84:91], v8
    v_smfmac_f32_16x16x64_bf16 v[32:35], v[28:31], v[84:91], v8
    v_smfmac_f32_32x32x32_bf16 v[148:163], v[128:131], v[92:99], v8
    v_smfmac_f32_16x16x64_bf16 v[32:35], v[28:31], v[92:99], v8
    s_add_u32 s8, s8, 4096
    s_cmp_lt_u32 s8, 262144
    s_cbranch_scc1 L_fb2
    s_nop 4
    v_mov_b32 v33, v32
    s_nop 1
    v_permlane32_swap_b32 v32, v33
    v_rcp_f32 v9, v32
    s_nop 15
    s_branch L_fin
L_helper:
    s_and_b32 s79, s7, 1
    s_lshr_b32 s38, s7, 1
    s_lshl_b32 s8, s6, 4
    s_add_u32 s39, s38, s8
    s_mov_b32 s10, s79
    s_sub_u32 s8, 256, s39
    s_cmp_eq_u32 s39, 0
    s_cselect_b32 s8, 128, s8
    s_cmp_eq_u32 s10, 0
    s_cselect_b32 s11, s39, s8
    v_mov_b32 v16, 252
    s_waitcnt lgkmcnt(0)
    s_cmp_lg_u32 s2, 0
    s_cbranch_scc1 L_nononce
    s_memrealtime s[8:9]
    s_waitcnt lgkmcnt(0)
    s_lshl_b32 s8, s8, 4
    s_or_b32 s8, s8, 8
    v_mov_b32 v17, s8
    s_mov_b64 exec, 1
    global_store_dword v16, v17, s[34:35] sc1
    s_mov_b64 exec, -1
L_nononce:
    s_getpc_b64 s[8:9]
L_pc:
    s_lshl_b32 s76, s7, 10
    v_and_b32 v14, 7, v0
    v_lshl_add_u32 v14, v14, 7, s76
    v_min_u32 v14, L_last-L_first, v14
    v_subrev_u32 v14, L_pc-L_first, v14
    v_ashrrev_i32 v31, 31, v14
    v_mov_b32 v15, s9
    v_add_co_u32 v30, vcc, s8, v14
    s_nop 1
    v_addc_co_u32 v31, vcc, v31, v15, vcc
    s_mov_b64 exec, 0xff
    global_load_dword v29, v[30:31], off
    s_mov_b64 exec, -1
    s_mov_b32 s44, s24
    s_mov_b32 s45, s25
    s_mov_b32 s46, 2097152
    s_mov_b32 s47, 0x20000
    v_lshrrev_b32 v9, 1, v0
    v_lshlrev_b32 v9, 11, v9
    v_and_b32 v14, 1, v0
    v_lshl_add_u32 v9, v14, 7, v9
    s_mov_b32 s8, s6
    s_xor_b32 s8, s5, s8
    s_lshl_b32 s8, s8, 2
    s_and_b32 s9, s7, 3
    s_xor_b32 s8, s8, s9
    s_lshl_b32 s8, s8, 16
    s_lshl_b32 s9, s5, 8
    s_add_u32 s8, s8, s9
    buffer_load_dword v28, v9, s[44:47], s8 offen
    s_mov_b32 s60, s36
    s_mov_b32 s61, s37
    s_mov_b32 s62, 16777216
    s_mov_b32 s63, 0x20000
    s_add_u32 s48, s36, 0
    s_addc_u32 s49, s37, 0
    s_mov_b32 s50, 262144
    s_mov_b32 s51, 0x20000
    v_lshlrev_b32 v8, 7, v0
    v_lshrrev_b32 v9, 1, v0
    v_lshlrev_b32 v9, 11, v9
    v_and_b32 v14, 1, v0
    v_lshl_add_u32 v9, v14, 7, v9
    s_and_b32 s8, s7, 3
    s_lshl_b32 s8, s8, 16
    s_lshl_b32 s9, s5, 8
    s_add_u32 s76, s8, s9
    v_lshrrev_b32 v19, 3, v0
    v_bfe_u32 v14, v19, 1, 1
    v_lshlrev_b32 v14, 2, v14
    v_xor_b32 v14, v14, v0
    v_and_b32 v14, 7, v14
    v_lshlrev_b32 v14, 4, v14
    v_lshl_add_u32 v19, v19, 15, v14
    s_lshl_b32 s8, s6, 11
    s_lshl_b32 s9, s38, 7
    s_add_u32 s8, s8, s9
    v_add_u32 v19, s8, v19
    v_xor_b32 v22, 32, v19
    v_lshrrev_b32 v24, 2, v0
    v_and_b32 v14, 3, v0
    v_lshlrev_b32 v14, 4, v14
    v_lshlrev_b32 v24, 11, v24
    s_lshl_b32 s9, s5, 8
    v_add3_u32 v24, v24, v14, s9
    s_lshl_b32 s100, s5, 1
    v_bfe_u32 v14, v0, 2, 3
    v_and_b32 v15, 1, v14
    v_lshlrev_b32 v15, 1, v15
    v_bfe_u32 v23, v14, 1, 1
    v_or_b32 v15, v15, v23
    v_and_b32 v23, 4, v14
    v_or_b32 v23, v23, v15
    v_lshlrev_b32 v23, 2, v23
    v_and_b32 v14, 3, v0
    v_or_b32 v23, v23, v14
    v_bfe_u32 v15, v0, 2, 2
    v_lshlrev_b32 v152, 15, v4
    v_lshl_add_u32 v152, v15, 11, v152
    v_lshl_add_u32 v152, v15, 6, v152
    v_lshl_add_u32 v152, v14, 3, v152
    v_bfe_u32 v14, v0, 4, 1
    v_lshl_add_u32 v152, v14, 5, v152
    v_add_u32 v152, 49152, v152
    v_and_b32 v14, 31, v0
    v_lshlrev_b32 v15, 4, v15
    v_lshl_add_u32 v153, v14, 6, v15
    v_lshl_add_u32 v153, v4, 13, v153
    v_add_u32 v153, 16384, v153
    v_bfe_u32 v15, v23, 2, 2
    v_xor_b32 v15, v15, v4
    v_lshlrev_b32 v15, 4, v15
    v_lshl_add_u32 v154, v23, 6, v15
    v_add_u32 v154, 16384, v154
    v_lshlrev_b32 v155, 6, v23
    v_lshl_add_u32 v155, v4, 4, v155
    s_and_b32 s8, s5, 1
    s_lshl_b32 s8, s8, 12
    s_bfe_u32 s9, s5, 0x10001
    s_cmp_ge_u32 s5, 4
    s_cbranch_scc1 L_vtype
    v_and_b32 v14, 31, v0
    v_lshlrev_b32 v11, 6, v14
    v_lshl_add_u32 v11, v4, 5, v11
    s_lshl_b32 s9, s9, 10
    s_add_u32 s8, s8, s9
    v_add_u32 v12, s8, v1
    s_branch L_kvj
L_vtype:
    v_and_b32 v14, 15, v0
    v_lshrrev_b32 v15, 4, v0
    v_lshlrev_b32 v11, 7, v14
    v_lshl_add_u32 v11, v15, 5, v11
    v_lshlrev_b32 v12, 9, v15
    v_and_b32 v15, 3, v0
    v_lshl_add_u32 v12, v15, 4, v12
    v_bfe_u32 v15, v0, 2, 1
    v_lshl_add_u32 v12, v15, 7, v12
    v_bfe_u32 v15, v0, 3, 1
    v_lshl_add_u32 v12, v15, 6, v12
    s_lshl_b32 s9, s9, 8
    s_add_u32 s8, s8, s9
    s_add_u32 s8, s8, 2048
    v_add_u32 v12, s8, v12
L_kvj:
    v_add_u32 v11, 49152, v11
    v_lshrrev_b32 v13, 1, v0
    v_lshlrev_b32 v13, 7, v13
    v_and_b32 v14, 1, v0
    v_lshl_add_u32 v13, v14, 4, v13
    s_lshl_b32 s78, s4, 7
    s_lshl_b32 s8, s5, 2
    s_add_u32 s78, s78, s8
    s_bfe_u32 s8, s2, 0x20003
    s_lshl_b32 s8, s8, 4
    v_lshrrev_b32 v14, 2, v0
    v_add_u32 v14, s8, v14
    s_lshr_b32 s77, s2, 7
    s_xor_b32 s9, s77, 1
    v_or_b32 v15, s9, v14
    v_cmp_eq_u32 vcc, 0, v15
    s_bfe_u32 s9, s2, 0x10002
    v_mov_b32 v165, s77
    v_mov_b32 v164, s9
    v_cndmask_b32 v14, v14, 64, vcc
    v_cndmask_b32 v165, v165, v164, vcc
    v_cvt_f32_u32 v14, v14
    v_cvt_f32_u32 v165, v165
    s_bfe_u32 s8, s2, 0x20005
    s_lshl_b32 s8, s8, 6
    s_add_u32 s9, s9, s8
    s_and_b32 s8, s2, 3
    s_lshl_b32 s8, s8, 4
    s_add_u32 s9, s9, s8
    v_and_b32 v15, 3, v0
    v_lshl_add_u32 v15, v15, 2, s9
    v_cvt_f32_u32 v15, v15
    v_mul_f32 v14, 0x3b800000, v14
    v_mul_f32 v165, 0x3e800000, v165
    v_fma_f32 v165, v14, v15, v165
    v_fma_f32 v14, v14, 2.0, v165
    v_cos_f32 v165, v165
    v_cos_f32 v14, v14
    s_lshl_b32 s8, s2, 8
    s_add_u32 s81, s8, 524288
    v_cvt_pk_bf16_f32 v21, v165, v14
    v_lshlrev_b32 v20, 2, v0
    s_mov_b32 s77, 0x3e000000
    v_cvt_f32_u32 v164, v23
    v_cvt_f32_u32 v10, v4
    v_mul_f32 v165, v164, v10
    v_mul_f32 v10, 0x3c000000, v165
    v_mul_f32 v165, 0x3e800000, v165
    v_fmamk_f32 v32, v164, 0x0, v10
    v_fmamk_f32 v33, v164, 0x3a800000, v10
    v_fmamk_f32 v34, v164, 0x3b000000, v10
    v_fmamk_f32 v35, v164, 0x3b400000, v10
    v_fmamk_f32 v36, v164, 0x3b800000, v10
    v_fmamk_f32 v37, v164, 0x3ba00000, v10
    v_fmamk_f32 v38, v164, 0x3bc00000, v10
    v_fmamk_f32 v39, v164, 0x3be00000, v10
    v_fmamk_f32 v40, v164, 0x3c800000, v10
    v_fmamk_f32 v41, v164, 0x3c880000, v10
    v_fmamk_f32 v42, v164, 0x3c900000, v10
    v_fmamk_f32 v43, v164, 0x3c980000, v10
    v_fmamk_f32 v44, v164, 0x3ca00000, v10
    v_fmamk_f32 v45, v164, 0x3ca80000, v10
    v_fmamk_f32 v46, v164, 0x3cb00000, v10
    v_fmamk_f32 v47, v164, 0x3cb80000, v10
    v_cos_f32 v120, v32
    v_sin_f32_e64 v136, -v32
    v_cos_f32 v121, v33
    v_sin_f32_e64 v137, -v33
    v_cos_f32 v122, v34
    v_sin_f32_e64 v138, -v34
    v_cos_f32 v123, v35
    v_sin_f32_e64 v139, -v35
    v_cos_f32 v124, v36
    v_sin_f32_e64 v140, -v36
    v_cos_f32 v125, v37
    v_sin_f32_e64 v141, -v37
    v_cos_f32 v126, v38
    v_sin_f32_e64 v142, -v38
    v_cos_f32 v127, v39
    v_sin_f32_e64 v143, -v39
    v_cos_f32 v128, v40
    v_sin_f32_e64 v144, -v40
    v_cos_f32 v129, v41
    v_sin_f32_e64 v145, -v41
    v_cos_f32 v130, v42
    v_sin_f32_e64 v146, -v42
    v_cos_f32 v131, v43
    v_sin_f32_e64 v147, -v43
    v_cos_f32 v132, v44
    v_sin_f32_e64 v148, -v44
    v_cos_f32 v133, v45
    v_sin_f32_e64 v149, -v45
    v_cos_f32 v134, v46
    v_sin_f32_e64 v150, -v46
    v_cos_f32 v135, v47
    v_sin_f32_e64 v151, -v47
    v_fmamk_f32 v32, v164, 0x0, v165
    v_fmamk_f32 v33, v164, 0x3d000000, v165
    v_fmamk_f32 v34, v164, 0x3d800000, v165
    v_fmamk_f32 v35, v164, 0x3dc00000, v165
    v_fmamk_f32 v36, v164, 0x3e000000, v165
    v_fmamk_f32 v37, v164, 0x3e200000, v165
    v_fmamk_f32 v38, v164, 0x3e400000, v165
    v_fmamk_f32 v39, v164, 0x3e600000, v165
    v_fmamk_f32 v40, v164, 0x3f000000, v165
    v_fmamk_f32 v41, v164, 0x3f080000, v165
    v_fmamk_f32 v42, v164, 0x3f100000, v165
    v_fmamk_f32 v43, v164, 0x3f180000, v165
    v_fmamk_f32 v44, v164, 0x3f200000, v165
    v_fmamk_f32 v45, v164, 0x3f280000, v165
    v_fmamk_f32 v46, v164, 0x3f300000, v165
    v_fmamk_f32 v47, v164, 0x3f380000, v165
    v_sin_f32 v48, v32
    v_cos_f32 v32, v32
    v_sin_f32 v49, v33
    v_cos_f32 v33, v33
    v_sin_f32 v50, v34
    v_cos_f32 v34, v34
    v_sin_f32 v51, v35
    v_cos_f32 v35, v35
    v_sin_f32 v52, v36
    v_cos_f32 v36, v36
    v_sin_f32 v53, v37
    v_cos_f32 v37, v37
    v_sin_f32 v54, v38
    v_cos_f32 v38, v38
    v_sin_f32 v55, v39
    v_cos_f32 v39, v39
    v_sin_f32 v56, v40
    v_cos_f32 v40, v40
    v_sin_f32 v57, v41
    v_cos_f32 v41, v41
    v_sin_f32 v58, v42
    v_cos_f32 v42, v42
    v_sin_f32 v59, v43
    v_cos_f32 v43, v43
    v_sin_f32 v60, v44
    v_cos_f32 v44, v44
    v_sin_f32 v61, v45
    v_cos_f32 v45, v45
    v_sin_f32 v62, v46
    v_cos_f32 v46, v46
    v_sin_f32 v63, v47
    v_cos_f32 v47, v47
    v_cvt_pk_bf16_f32 v156, v48, v49
    v_cvt_pk_bf16_f32 v104, v32, v33
    v_cvt_pk_bf16_f32 v157, v50, v51
    v_cvt_pk_bf16_f32 v105, v34, v35
    v_cvt_pk_bf16_f32 v158, v52, v53
    v_cvt_pk_bf16_f32 v106, v36, v37
    v_cvt_pk_bf16_f32 v159, v54, v55
    v_cvt_pk_bf16_f32 v107, v38, v39
    v_cvt_pk_bf16_f32 v160, v56, v57
    v_cvt_pk_bf16_f32 v108, v40, v41
    v_cvt_pk_bf16_f32 v161, v58, v59
    v_cvt_pk_bf16_f32 v109, v42, v43
    v_cvt_pk_bf16_f32 v162, v60, v61
    v_cvt_pk_bf16_f32 v110, v44, v45
    v_cvt_pk_bf16_f32 v163, v62, v63
    v_cvt_pk_bf16_f32 v111, v46, v47
    v_xor_b32 v112, 0x80008000, v156
    v_xor_b32 v113, 0x80008000, v157
    v_xor_b32 v114, 0x80008000, v158
    v_xor_b32 v115, 0x80008000, v159
    v_xor_b32 v116, 0x80008000, v160
    v_xor_b32 v117, 0x80008000, v161
    v_xor_b32 v118, 0x80008000, v162
    v_xor_b32 v119, 0x80008000, v163
    v_bfe_u32 v164, v0, 1, 3
    v_lshlrev_b32 v164, 8, v164
    v_add_u32 v164, s11, v164
    v_cvt_f32_u32 v164, v164
    s_lshl_b32 s8, s10, 1
    s_add_u32 s8, s8, 3
    v_mul_u32_u24 v165, s8, v4
    v_and_b32 v10, 1, v0
    v_add_u32 v165, v165, v10
    v_and_b32 v165, 3, v165
    v_cvt_f32_u32 v165, v165
    v_mul_f32 v165, 0x3e800000, v165
    s_cmp_eq_u32 s39, 0
    s_cselect_b32 s8, 1, 0
    v_and_b32 v10, s8, v4
    v_bfe_u32 v14, v0, 4, 1
    v_or_b32 v10, v10, v14
    v_add_u32 v10, -1, v10
    s_cmp_eq_u32 s10, 0
    s_cselect_b32 s8, 0xbe000000, s77
    s_cmp_eq_u32 s39, 64
    s_cselect_b32 s8, s8, 0
    s_cselect_b32 s9, 0x3f3504f3, 1.0
    v_add_f32 v165, s8, v165
    v_fmamk_f32 v32, v164, 0x0, v165
    v_fmamk_f32 v33, v164, 0x3a000000, v165
    v_fmamk_f32 v34, v164, 0x3a800000, v165
    v_fmamk_f32 v35, v164, 0x3ac00000, v165
    v_fmamk_f32 v36, v164, 0x3b000000, v165
    v_fmamk_f32 v37, v164, 0x3b200000, v165
    v_fmamk_f32 v38, v164, 0x3b400000, v165
    v_fmamk_f32 v39, v164, 0x3b600000, v165
    v_cos_f32 v32, v32
    v_cos_f32 v33, v33
    v_cos_f32 v34, v34
    v_cos_f32 v35, v35
    v_cos_f32 v36, v36
    v_cos_f32 v37, v37
    v_cos_f32 v38, v38
    v_cos_f32 v39, v39
    s_nop 0
    v_mul_f32 v32, s9, v32
    v_mul_f32 v33, s9, v33
    v_mul_f32 v34, s9, v34
    v_mul_f32 v35, s9, v35
    v_mul_f32 v36, s9, v36
    v_mul_f32 v37, s9, v37
    v_mul_f32 v38, s9, v38
    v_mul_f32 v39, s9, v39
    v_cvt_pk_bf16_f32 v96, v32, v33
    v_cvt_pk_bf16_f32 v97, v34, v35
    v_cvt_pk_bf16_f32 v98, v36, v37
    v_cvt_pk_bf16_f32 v99, v38, v39
    v_and_b32 v96, v96, v10
    v_and_b32 v97, v97, v10
    v_and_b32 v98, v98, v10
    v_and_b32 v99, v99, v10
    s_setprio 3
    s_barrier
    s_barrier
    s_load_dword s101, s[34:35], 252
    s_barrier
    s_barrier
    ds_read_b128 v[32:35], v11 offset:0
    ds_read_b128 v[36:39], v11 offset:16
    ds_read_b128 v[40:43], v11 offset:2048
    ds_read_b128 v[44:47], v11 offset:2064
    ds_read_b128 v[48:51], v11 offset:4096
    ds_read_b128 v[52:55], v11 offset:4112
    ds_read_b128 v[56:59], v11 offset:6144
    ds_read_b128 v[60:63], v11 offset:6160
    ds_read_b128 v[64:67], v11 offset:8192
    ds_read_b128 v[68:71], v11 offset:8208
    ds_read_b128 v[72:75], v11 offset:10240
    ds_read_b128 v[76:79], v11 offset:10256
    s_waitcnt lgkmcnt(8)
    ds_read_b128 v[80:83], v11 offset:12288
    ds_read_b128 v[84:87], v11 offset:12304
    ds_read_b128 v[88:91], v11 offset:14336
    ds_read_b128 v[92:95], v11 offset:14352
    s_waitcnt lgkmcnt(0)
    s_barrier
    v_add_f32 v32, v32, v64
    v_add_f32 v33, v33, v65
    v_add_f32 v34, v34, v66
    v_add_f32 v35, v35, v67
    v_add_f32 v36, v36, v68
    v_add_f32 v37, v37, v69
    v_add_f32 v38, v38, v70
    v_add_f32 v39, v39, v71
    v_add_f32 v40, v40, v72
    v_add_f32 v41, v41, v73
    v_add_f32 v42, v42, v74
    v_add_f32 v43, v43, v75
    v_add_f32 v44, v44, v76
    v_add_f32 v45, v45, v77
    v_add_f32 v46, v46, v78
    v_add_f32 v47, v47, v79
    v_add_f32 v48, v48, v80
    v_add_f32 v49, v49, v81
    v_add_f32 v50, v50, v82
    v_add_f32 v51, v51, v83
    v_add_f32 v52, v52, v84
    v_add_f32 v53, v53, v85
    v_add_f32 v54, v54, v86
    v_add_f32 v55, v55, v87
    v_add_f32 v56, v56, v88
    v_add_f32 v57, v57, v89
    v_add_f32 v58, v58, v90
    v_add_f32 v59, v59, v91
    v_add_f32 v60, v60, v92
    v_add_f32 v61, v61, v93
    v_add_f32 v62, v62, v94
    v_add_f32 v63, v63, v95
    v_add_f32 v32, v32, v48
    v_add_f32 v33, v33, v49
    v_add_f32 v34, v34, v50
    v_add_f32 v35, v35, v51
    v_add_f32 v36, v36, v52
    v_add_f32 v37, v37, v53
    v_add_f32 v38, v38, v54
    v_add_f32 v39, v39, v55
    v_add_f32 v40, v40, v56
    v_add_f32 v41, v41, v57
    v_add_f32 v42, v42, v58
    v_add_f32 v43, v43, v59
    v_add_f32 v44, v44, v60
    v_add_f32 v45, v45, v61
    v_add_f32 v46, v46, v62
    v_add_f32 v47, v47, v63
    v_add_f32 v32, v32, v40
    v_add_f32 v33, v33, v41
    v_add_f32 v34, v34, v42
    v_add_f32 v35, v35, v43
    v_add_f32 v36, v36, v44
    v_add_f32 v37, v37, v45
    v_add_f32 v38, v38, v46
    v_add_f32 v39, v39, v47
    s_cmp_ge_u32 s5, 4
    s_cselect_b32 s8, 1.0, 1048744942
    v_mul_f32 v32, s8, v32
    v_mul_f32 v33, s8, v33
    v_mul_f32 v34, s8, v34
    v_mul_f32 v35, s8, v35
    v_mul_f32 v36, s8, v36
    v_mul_f32 v37, s8, v37
    v_mul_f32 v38, s8, v38
    v_mul_f32 v39, s8, v39
    v_cvt_pk_bf16_f32 v32, v32, v33
    v_cvt_pk_bf16_f32 v33, v34, v35
    v_cvt_pk_bf16_f32 v34, v36, v37
    v_cvt_pk_bf16_f32 v35, v38, v39
    s_lshl_b32 s8, s4, 13
    buffer_store_dwordx4 v[32:35], v12, s[60:63], s8 offen sc1
    buffer_store_dword v21, v20, s[60:63], s81 offen sc1
    s_mov_b32 s98, 0
L_nw:
    s_waitcnt vmcnt(0)
    s_cmp_lg_u32 s101, 0
    s_cbranch_scc1 L_nok
    global_load_dword v15, v16, s[34:35] sc1
    s_add_u32 s98, s98, 1
    s_waitcnt vmcnt(0)
    v_readfirstlane_b32 s101, v15
    s_cmp_lt_u32 s98, 0x8000
    s_cbranch_scc1 L_nw
L_nok:
    s_getreg_b32 s8, hwreg(HW_REG_XCC_ID, 0, 3)
    s_or_b32 s86, s101, s8
    s_add_u32 s8, s78, 1048576
    v_mov_b32 v17, s86
    v_mov_b32 v18, 0
    s_mov_b64 exec, 1
    buffer_store_dword v17, v18, s[60:63], s8 offen sc1
    s_mov_b64 exec, -1
    s_barrier
    s_lshl_b32 s8, s6, 9
    s_add_u32 s99, s8, 1048576
    s_lshl_b32 s84, s6, 15
    s_load_dwordx8 s[40:47], s[36:37], s99 offset:0
    s_load_dwordx8 s[52:59], s[36:37], s99 offset:128
    s_load_dwordx8 s[64:71], s[36:37], s99 offset:256
    s_load_dwordx8 s[88:95], s[36:37], s99 offset:384
    s_waitcnt lgkmcnt(0)
    s_xor_b32 s40, s40, s101
    s_xor_b32 s41, s41, s101
    s_xor_b32 s42, s42, s101
    s_xor_b32 s43, s43, s101
    s_xor_b32 s44, s44, s101
    s_xor_b32 s45, s45, s101
    s_xor_b32 s46, s46, s101
    s_xor_b32 s47, s47, s101
    s_or_b64 s[40:41], s[40:41], s[42:43]
    s_or_b64 s[40:41], s[40:41], s[44:45]
    s_or_b64 s[40:41], s[40:41], s[46:47]
    s_xor_b32 s52, s52, s101
    s_xor_b32 s53, s53, s101
    s_xor_b32 s54, s54, s101
    s_xor_b32 s55, s55, s101
    s_xor_b32 s56, s56, s101
    s_xor_b32 s57, s57, s101
    s_xor_b32 s58, s58, s101
    s_xor_b32 s59, s59, s101
    s_or_b64 s[40:41], s[40:41], s[52:53]
    s_or_b64 s[40:41], s[40:41], s[54:55]
    s_or_b64 s[40:41], s[40:41], s[56:57]
    s_or_b64 s[40:41], s[40:41], s[58:59]
    s_xor_b32 s64, s64, s101
    s_xor_b32 s65, s65, s101
    s_xor_b32 s66, s66, s101
    s_xor_b32 s67, s67, s101
    s_xor_b32 s68, s68, s101
    s_xor_b32 s69, s69, s101
    s_xor_b32 s70, s70, s101
    s_xor_b32 s71, s71, s101
    s_or_b64 s[40:41], s[40:41], s[64:65]
    s_or_b64 s[40:41], s[40:41], s[66:67]
    s_or_b64 s[40:41], s[40:41], s[68:69]
    s_or_b64 s[40:41], s[40:41], s[70:71]
    s_xor_b32 s88, s88, s101
    s_xor_b32 s89, s89, s101
    s_xor_b32 s90, s90, s101
    s_xor_b32 s91, s91, s101
    s_xor_b32 s92, s92, s101
    s_xor_b32 s93, s93, s101
    s_xor_b32 s94, s94, s101
    s_xor_b32 s95, s95, s101
    s_or_b64 s[40:41], s[40:41], s[88:89]
    s_or_b64 s[40:41], s[40:41], s[90:91]
    s_or_b64 s[40:41], s[40:41], s[92:93]
    s_or_b64 s[40:41], s[40:41], s[94:95]
    s_or_b32 s8, s40, s41
    s_cmp_gt_u32 s8, 7
    s_cbranch_scc0 L_kvseen
    v_and_b32 v15, 0x1ff, v13
    s_mov_b32 s98, 0
L_pl1:
    buffer_load_dwordx4 v[28:31], v15, s[60:63], s99 offen sc1
L_pc1:
    s_add_u32 s98, s98, 1
    s_waitcnt vmcnt(0)
    v_xor_b32 v28, s86, v28
    v_xor_b32 v29, s86, v29
    v_xor_b32 v30, s86, v30
    v_xor_b32 v31, s86, v31
    v_or3_b32 v28, v28, v29, v30
    v_or_b32 v28, v28, v31
    v_cmp_lt_u32 vcc, 7, v28
    s_nop 0
    s_cmp_lg_u64 vcc, 0
    s_cbranch_scc0 L_po1
    s_cmp_lt_u32 s98, 0x8000
    s_cbranch_scc1 L_pl1
L_po1:
L_kvseen:
    s_mov_b32 m0, 0
    s_mov_b32 s9, s84
    s_mov_b32 s98, 0
L_hl2:
    buffer_load_dwordx4 v1, s[48:51], s9 offen offset:0 sc1 lds
    buffer_load_dwordx4 v1, s[48:51], s9 offen offset:1024 sc1 lds
    buffer_load_dwordx4 v1, s[48:51], s9 offen offset:2048 sc1 lds
    buffer_load_dwordx4 v1, s[48:51], s9 offen offset:3072 sc1 lds
    s_add_u32 m0, m0, 4096
    s_add_u32 s9, s9, 4096
    s_add_u32 s98, s98, 1
    s_cmp_lt_u32 s98, 4
    s_cbranch_scc1 L_hl2
    s_mov_b32 s68, s30
    s_mov_b32 s69, s31
    s_mov_b32 s70, 2097152
    s_mov_b32 s71, 0x20000
    s_mov_b32 s52, s12
    s_mov_b32 s53, s13
    s_mov_b32 s54, 4194304
    s_mov_b32 s55, 0x20000
    s_add_u32 s84, s84, 16384
    s_waitcnt vmcnt(0)
    s_barrier
    s_mov_b32 m0, 16384
    s_mov_b32 s9, s84
    s_mov_b32 s98, 0
L_hl3:
    buffer_load_dwordx4 v1, s[48:51], s9 offen offset:0 sc1 lds
    buffer_load_dwordx4 v1, s[48:51], s9 offen offset:1024 sc1 lds
    buffer_load_dwordx4 v1, s[48:51], s9 offen offset:2048 sc1 lds
    buffer_load_dwordx4 v1, s[48:51], s9 offen offset:3072 sc1 lds
    s_add_u32 m0, m0, 4096
    s_add_u32 s9, s9, 4096
    s_add_u32 s98, s98, 1
    s_cmp_lt_u32 s98, 4
    s_cbranch_scc1 L_hl3
    v_add_u32 v11, 65536, v1
    ds_write_b128 v11, v[96:99] offset:0
    ds_write_b128 v11, v[104:107] offset:1024
    ds_write_b128 v11, v[108:111] offset:2048
    ds_write_b128 v11, v[112:115] offset:3072
    ds_write_b128 v11, v[116:119] offset:4096
    ds_write_b128 v11, v[156:159] offset:5120
    ds_write_b128 v11, v[160:163] offset:6144
    ds_write_b128 v11, v[120:123] offset:7168
    ds_write_b128 v11, v[124:127] offset:8192
    ds_write_b128 v11, v[128:131] offset:9216
    ds_write_b128 v11, v[132:135] offset:10240
    ds_write_b128 v11, v[136:139] offset:11264
    ds_write_b128 v11, v[140:143] offset:12288
    ds_write_b128 v11, v[144:147] offset:13312
    ds_write_b128 v11, v[148:151] offset:14336
    s_mov_b32 s99, 1048576
    s_mov_b32 s98, 0
L_pl4:
    buffer_load_dwordx4 v[28:31], v13, s[60:63], s99 offen sc1
L_pc4:
    s_add_u32 s98, s98, 1
    s_waitcnt vmcnt(0)
    v_xor_b32 v28, s86, v28
    v_xor_b32 v29, s86, v29
    v_xor_b32 v30, s86, v30
    v_xor_b32 v31, s86, v31
    v_or3_b32 v28, v28, v29, v30
    v_or_b32 v28, v28, v31
    v_cmp_lt_u32 vcc, 7, v28
    s_nop 0
    s_cmp_lg_u64 vcc, 0
    s_cbranch_scc0 L_po4
    s_cmp_lt_u32 s98, 0x8000
    s_cbranch_scc1 L_pl4
L_po4:
    v_cmp_ne_u32 vcc, 0, v28
    s_lshl_b32 s8, s4, 1
    s_lshr_b64 vcc, vcc, s8
    s_and_b32 s8, vcc_lo, 3
    s_cselect_b32 s85, 0, 1
    v_or_b32 v155, s85, v155
    ds_write_b128 v11, v[152:155] offset:15360
    s_lshl_b32 s8, s7, 13
    buffer_load_dword v10, v8, s[48:51], s8 offen sc1
    v_lshrrev_b32 v12, 3, v0
    v_xor_b32 v14, v12, v0
    v_and_b32 v14, 7, v14
    v_lshlrev_b32 v14, 4, v14
    s_lshl_b32 s8, s79, 21
    s_lshl_b32 s9, s6, 11
    s_add_u32 s8, s8, s9
    s_lshl_b32 s9, s38, 7
    s_add_u32 s8, s8, s9
    s_add_u32 s8, s8, 10485760
    v_add_u32 v14, s8, v14
    v_lshl_add_u32 v20, v12, 14, v14
    v_sub_u32 v15, 72, v12
    v_lshl_add_u32 v21, v15, 14, v14
    v_cmp_eq_u32 vcc, 0, v12
    s_lshl_b32 s8, s79, 20
    v_mov_b32 v14, s8
    v_cndmask_b32 v14, 0, v14, vcc
    v_sub_u32 v164, v20, v14
    v_sub_u32 v165, v21, v14
    s_lshl_b32 s81, s79, 15
    s_add_u32 s81, s81, 524288
    s_barrier
    s_add_u32 s84, s84, 16384
    s_and_b32 s84, s84, 262143
    s_mov_b32 m0, 32768
    s_mov_b32 s9, s84
    s_mov_b32 s98, 0
L_hl5:
    buffer_load_dwordx4 v1, s[48:51], s9 offen offset:0 sc1 lds
    buffer_load_dwordx4 v1, s[48:51], s9 offen offset:1024 sc1 lds
    buffer_load_dwordx4 v1, s[48:51], s9 offen offset:2048 sc1 lds
    buffer_load_dwordx4 v1, s[48:51], s9 offen offset:3072 sc1 lds
    s_add_u32 m0, m0, 4096
    s_add_u32 s9, s9, 4096
    s_add_u32 s98, s98, 1
    s_cmp_lt_u32 s98, 4
    s_cbranch_scc1 L_hl5
    s_mov_b32 m0, 81920
    s_mov_b32 s9, 0
    s_mov_b32 s98, 0
L_hl6:
    buffer_load_dwordx4 v19, s[52:55], s9 offen  lds
    s_add_u32 s8, s9, 261120
    buffer_load_dwordx4 v22, s[52:55], s8 offen offset:1024  lds
    s_add_u32 m0, m0, 2048
    s_add_u32 s9, s9, 524288
    s_add_u32 s98, s98, 1
    s_cmp_lt_u32 s98, 2
    s_cbranch_scc1 L_hl6
    s_mov_b32 m0, 86016
    s_mov_b32 s9, 16384
    s_mov_b32 s98, 0
L_hl7:
    buffer_load_dwordx4 v19, s[52:55], s9 offen  lds
    s_add_u32 s8, s9, 261120
    buffer_load_dwordx4 v22, s[52:55], s8 offen offset:1024  lds
    s_add_u32 m0, m0, 2048
    s_add_u32 s9, s9, 524288
    s_add_u32 s98, s98, 1
    s_cmp_lt_u32 s98, 2
    s_cbranch_scc1 L_hl7
    s_add_u32 s8, s81, 0
    s_mov_b32 m0, 90112
    s_mov_b32 s9, s8
    s_mov_b32 s98, 0
L_hl8:
    buffer_load_dwordx4 v1, s[60:63], s9 offen offset:0 sc1 lds
    buffer_load_dwordx4 v1, s[60:63], s9 offen offset:1024 sc1 lds
    buffer_load_dwordx4 v1, s[60:63], s9 offen offset:2048 sc1 lds
    buffer_load_dwordx4 v1, s[60:63], s9 offen offset:3072 sc1 lds
    s_add_u32 m0, m0, 4096
    s_add_u32 s9, s9, 4096
    s_add_u32 s98, s98, 1
    s_cmp_lt_u32 s98, 2
    s_cbranch_scc1 L_hl8
    s_waitcnt vmcnt(16)
    s_barrier
    s_add_u32 s84, s84, 16384
    s_and_b32 s84, s84, 262143
    s_mov_b32 m0, 0
    s_mov_b32 s9, s84
    s_mov_b32 s98, 0
L_hl9:
    buffer_load_dwordx4 v1, s[48:51], s9 offen offset:0 sc1 lds
    buffer_load_dwordx4 v1, s[48:51], s9 offen offset:1024 sc1 lds
    buffer_load_dwordx4 v1, s[48:51], s9 offen offset:2048 sc1 lds
    buffer_load_dwordx4 v1, s[48:51], s9 offen offset:3072 sc1 lds
    s_add_u32 m0, m0, 4096
    s_add_u32 s9, s9, 4096
    s_add_u32 s98, s98, 1
    s_cmp_lt_u32 s98, 4
    s_cbranch_scc1 L_hl9
    s_mov_b32 m0, 98304
    s_mov_b32 s9, 1048576
    s_mov_b32 s98, 0
L_hl10:
    buffer_load_dwordx4 v19, s[52:55], s9 offen  lds
    s_add_u32 s8, s9, 261120
    buffer_load_dwordx4 v22, s[52:55], s8 offen offset:1024  lds
    s_add_u32 m0, m0, 2048
    s_add_u32 s9, s9, 524288
    s_add_u32 s98, s98, 1
    s_cmp_lt_u32 s98, 2
    s_cbranch_scc1 L_hl10
    s_mov_b32 m0, 102400
    s_mov_b32 s9, 1064960
    s_mov_b32 s98, 0
L_hl11:
    buffer_load_dwordx4 v19, s[52:55], s9 offen  lds
    s_add_u32 s8, s9, 261120
    buffer_load_dwordx4 v22, s[52:55], s8 offen offset:1024  lds
    s_add_u32 m0, m0, 2048
    s_add_u32 s9, s9, 524288
    s_add_u32 s98, s98, 1
    s_cmp_lt_u32 s98, 2
    s_cbranch_scc1 L_hl11
    s_add_u32 s8, s81, 8192
    s_mov_b32 m0, 106496
    s_mov_b32 s9, s8
    s_mov_b32 s98, 0
L_hl12:
    buffer_load_dwordx4 v1, s[60:63], s9 offen offset:0 sc1 lds
    buffer_load_dwordx4 v1, s[60:63], s9 offen offset:1024 sc1 lds
    buffer_load_dwordx4 v1, s[60:63], s9 offen offset:2048 sc1 lds
    buffer_load_dwordx4 v1, s[60:63], s9 offen offset:3072 sc1 lds
    s_add_u32 m0, m0, 4096
    s_add_u32 s9, s9, 4096
    s_add_u32 s98, s98, 1
    s_cmp_lt_u32 s98, 2
    s_cbranch_scc1 L_hl12
    s_waitcnt vmcnt(16)
    s_barrier
    s_add_u32 s84, s84, 16384
    s_and_b32 s84, s84, 262143
    s_mov_b32 m0, 16384
    s_mov_b32 s9, s84
    s_mov_b32 s98, 0
L_hl13:
    buffer_load_dwordx4 v1, s[48:51], s9 offen offset:0 sc1 lds
    buffer_load_dwordx4 v1, s[48:51], s9 offen offset:1024 sc1 lds
    buffer_load_dwordx4 v1, s[48:51], s9 offen offset:2048 sc1 lds
    buffer_load_dwordx4 v1, s[48:51], s9 offen offset:3072 sc1 lds
    s_add_u32 m0, m0, 4096
    s_add_u32 s9, s9, 4096
    s_add_u32 s98, s98, 1
    s_cmp_lt_u32 s98, 4
    s_cbranch_scc1 L_hl13
    s_mov_b32 m0, 114688
    s_mov_b32 s9, 2097152
    s_mov_b32 s98, 0
L_hl14:
    buffer_load_dwordx4 v19, s[52:55], s9 offen  lds
    s_add_u32 s8, s9, 261120
    buffer_load_dwordx4 v22, s[52:55], s8 offen offset:1024  lds
    s_add_u32 m0, m0, 2048
    s_add_u32 s9, s9, 524288
    s_add_u32 s98, s98, 1
    s_cmp_lt_u32 s98, 2
    s_cbranch_scc1 L_hl14
    s_mov_b32 m0, 118784
    s_mov_b32 s9, 2113536
    s_mov_b32 s98, 0
L_hl15:
    buffer_load_dwordx4 v19, s[52:55], s9 offen  lds
    s_add_u32 s8, s9, 261120
    buffer_load_dwordx4 v22, s[52:55], s8 offen offset:1024  lds
    s_add_u32 m0, m0, 2048
    s_add_u32 s9, s9, 524288
    s_add_u32 s98, s98, 1
    s_cmp_lt_u32 s98, 2
    s_cbranch_scc1 L_hl15
    s_add_u32 s8, s81, 16384
    s_mov_b32 m0, 122880
    s_mov_b32 s9, s8
    s_mov_b32 s98, 0
L_hl16:
    buffer_load_dwordx4 v1, s[60:63], s9 offen offset:0 sc1 lds
    buffer_load_dwordx4 v1, s[60:63], s9 offen offset:1024 sc1 lds
    buffer_load_dwordx4 v1, s[60:63], s9 offen offset:2048 sc1 lds
    buffer_load_dwordx4 v1, s[60:63], s9 offen offset:3072 sc1 lds
    s_add_u32 m0, m0, 4096
    s_add_u32 s9, s9, 4096
    s_add_u32 s98, s98, 1
    s_cmp_lt_u32 s98, 2
    s_cbranch_scc1 L_hl16
    s_waitcnt vmcnt(16)
    s_barrier
    s_add_u32 s84, s84, 16384
    s_and_b32 s84, s84, 262143
    s_mov_b32 m0, 32768
    s_mov_b32 s9, s84
    s_mov_b32 s98, 0
L_hl17:
    buffer_load_dwordx4 v1, s[48:51], s9 offen offset:0 sc1 lds
    buffer_load_dwordx4 v1, s[48:51], s9 offen offset:1024 sc1 lds
    buffer_load_dwordx4 v1, s[48:51], s9 offen offset:2048 sc1 lds
    buffer_load_dwordx4 v1, s[48:51], s9 offen offset:3072 sc1 lds
    s_add_u32 m0, m0, 4096
    s_add_u32 s9, s9, 4096
    s_add_u32 s98, s98, 1
    s_cmp_lt_u32 s98, 4
    s_cbranch_scc1 L_hl17
    s_mov_b32 m0, 131072
    s_mov_b32 s9, 3145728
    s_mov_b32 s98, 0
L_hl18:
    buffer_load_dwordx4 v19, s[52:55], s9 offen  lds
    s_add_u32 s8, s9, 261120
    buffer_load_dwordx4 v22, s[52:55], s8 offen offset:1024  lds
    s_add_u32 m0, m0, 2048
    s_add_u32 s9, s9, 524288
    s_add_u32 s98, s98, 1
    s_cmp_lt_u32 s98, 2
    s_cbranch_scc1 L_hl18
    s_mov_b32 m0, 135168
    s_mov_b32 s9, 3162112
    s_mov_b32 s98, 0
L_hl19:
    buffer_load_dwordx4 v19, s[52:55], s9 offen  lds
    s_add_u32 s8, s9, 261120
    buffer_load_dwordx4 v22, s[52:55], s8 offen offset:1024  lds
    s_add_u32 m0, m0, 2048
    s_add_u32 s9, s9, 524288
    s_add_u32 s98, s98, 1
    s_cmp_lt_u32 s98, 2
    s_cbranch_scc1 L_hl19
    s_add_u32 s8, s81, 24576
    s_mov_b32 m0, 139264
    s_mov_b32 s9, s8
    s_mov_b32 s98, 0
L_hl20:
    buffer_load_dwordx4 v1, s[60:63], s9 offen offset:0 sc1 lds
    buffer_load_dwordx4 v1, s[60:63], s9 offen offset:1024 sc1 lds
    buffer_load_dwordx4 v1, s[60:63], s9 offen offset:2048 sc1 lds
    buffer_load_dwordx4 v1, s[60:63], s9 offen offset:3072 sc1 lds
    s_add_u32 m0, m0, 4096
    s_add_u32 s9, s9, 4096
    s_add_u32 s98, s98, 1
    s_cmp_lt_u32 s98, 2
    s_cbranch_scc1 L_hl20
    s_waitcnt vmcnt(16)
    s_barrier
    s_add_u32 s84, s84, 16384
    s_and_b32 s84, s84, 262143
    s_mov_b32 m0, 0
    s_mov_b32 s9, s84
    s_mov_b32 s98, 0
L_hl21:
    buffer_load_dwordx4 v1, s[48:51], s9 offen offset:0 sc1 lds
    buffer_load_dwordx4 v1, s[48:51], s9 offen offset:1024 sc1 lds
    buffer_load_dwordx4 v1, s[48:51], s9 offen offset:2048 sc1 lds
    buffer_load_dwordx4 v1, s[48:51], s9 offen offset:3072 sc1 lds
    s_add_u32 m0, m0, 4096
    s_add_u32 s9, s9, 4096
    s_add_u32 s98, s98, 1
    s_cmp_lt_u32 s98, 4
    s_cbranch_scc1 L_hl21
    s_lshl_b32 s8, s5, 18
    s_xor_b32 s8, s8, 524288
    s_add_u32 s8, s8, s76
    buffer_load_dword v10, v9, s[68:71], s8 offen
    s_lshl_b32 s8, s5, 18
    s_xor_b32 s8, s8, 786432
    s_add_u32 s8, s8, s76
    buffer_load_dword v10, v9, s[68:71], s8 offen
    s_waitcnt vmcnt(2)
    s_barrier
    s_add_u32 s84, s84, 16384
    s_and_b32 s84, s84, 262143
    s_mov_b32 m0, 16384
    s_mov_b32 s9, s84
    s_mov_b32 s98, 0
L_hl22:
    buffer_load_dwordx4 v1, s[48:51], s9 offen offset:0 sc1 lds
    buffer_load_dwordx4 v1, s[48:51], s9 offen offset:1024 sc1 lds
    buffer_load_dwordx4 v1, s[48:51], s9 offen offset:2048 sc1 lds
    buffer_load_dwordx4 v1, s[48:51], s9 offen offset:3072 sc1 lds
    s_add_u32 m0, m0, 4096
    s_add_u32 s9, s9, 4096
    s_add_u32 s98, s98, 1
    s_cmp_lt_u32 s98, 4
    s_cbranch_scc1 L_hl22
    s_lshl_b32 s8, s5, 18
    s_xor_b32 s8, s8, 1048576
    s_add_u32 s8, s8, s76
    buffer_load_dword v10, v9, s[68:71], s8 offen
    s_lshl_b32 s8, s5, 18
    s_xor_b32 s8, s8, 1310720
    s_add_u32 s8, s8, s76
    buffer_load_dword v10, v9, s[68:71], s8 offen
    s_waitcnt vmcnt(2)
    s_barrier
    s_add_u32 s84, s84, 16384
    s_and_b32 s84, s84, 262143
    s_mov_b32 m0, 32768
    s_mov_b32 s9, s84
    s_mov_b32 s98, 0
L_hl23:
    buffer_load_dwordx4 v1, s[48:51], s9 offen offset:0 sc1 lds
    buffer_load_dwordx4 v1, s[48:51], s9 offen offset:1024 sc1 lds
    buffer_load_dwordx4 v1, s[48:51], s9 offen offset:2048 sc1 lds
    buffer_load_dwordx4 v1, s[48:51], s9 offen offset:3072 sc1 lds
    s_add_u32 m0, m0, 4096
    s_add_u32 s9, s9, 4096
    s_add_u32 s98, s98, 1
    s_cmp_lt_u32 s98, 4
    s_cbranch_scc1 L_hl23
    s_lshl_b32 s8, s5, 18
    s_xor_b32 s8, s8, 1572864
    s_add_u32 s8, s8, s76
    buffer_load_dword v10, v9, s[68:71], s8 offen
    s_lshl_b32 s8, s5, 18
    s_xor_b32 s8, s8, 1835008
    s_add_u32 s8, s8, s76
    buffer_load_dword v10, v9, s[68:71], s8 offen
    s_lshl_b32 s8, s4, 17
    s_lshl_b32 s9, s5, 14
    s_add_u32 s8, s8, s9
    s_add_u32 s8, s8, 6291456
    buffer_load_dword v10, v8, s[60:63], s8 offen
    s_add_u32 s8, s8, 8192
    buffer_load_dword v10, v8, s[60:63], s8 offen
    s_waitcnt vmcnt(4)
    s_barrier
    s_add_u32 s84, s84, 16384
    s_and_b32 s84, s84, 262143
    s_mov_b32 m0, 0
    s_mov_b32 s9, s84
    s_mov_b32 s98, 0
L_hl24:
    buffer_load_dwordx4 v1, s[48:51], s9 offen offset:0 sc1 lds
    buffer_load_dwordx4 v1, s[48:51], s9 offen offset:1024 sc1 lds
    buffer_load_dwordx4 v1, s[48:51], s9 offen offset:2048 sc1 lds
    buffer_load_dwordx4 v1, s[48:51], s9 offen offset:3072 sc1 lds
    s_add_u32 m0, m0, 4096
    s_add_u32 s9, s9, 4096
    s_add_u32 s98, s98, 1
    s_cmp_lt_u32 s98, 4
    s_cbranch_scc1 L_hl24
    v_add_u32 v14, 81920, v1
    s_mov_b32 s8, 0
    ds_read_b128 v[32:35], v14 offset:0
    ds_read_b128 v[36:39], v14 offset:1024
    ds_read_b128 v[40:43], v14 offset:2048
    ds_read_b128 v[44:47], v14 offset:3072
    ds_read_b128 v[48:51], v14 offset:4096
    ds_read_b128 v[52:55], v14 offset:5120
    ds_read_b128 v[56:59], v14 offset:6144
    ds_read_b128 v[60:63], v14 offset:7168
    s_waitcnt lgkmcnt(7)
    buffer_store_dwordx4 v[32:35], v164, s[60:63], s8 offen sc1
    s_add_u32 s8, s8, 131072
    s_waitcnt lgkmcnt(6)
    buffer_store_dwordx4 v[36:39], v20, s[60:63], s8 offen sc1
    s_add_u32 s8, s8, 131072
    s_waitcnt lgkmcnt(5)
    buffer_store_dwordx4 v[40:43], v20, s[60:63], s8 offen sc1
    s_add_u32 s8, s8, 131072
    s_waitcnt lgkmcnt(4)
    buffer_store_dwordx4 v[44:47], v20, s[60:63], s8 offen sc1
    s_add_u32 s8, s8, 131072
    s_waitcnt lgkmcnt(3)
    buffer_store_dwordx4 v[48:51], v20, s[60:63], s8 offen sc1
    s_add_u32 s8, s8, 131072
    s_waitcnt lgkmcnt(2)
    buffer_store_dwordx4 v[52:55], v20, s[60:63], s8 offen sc1
    s_add_u32 s8, s8, 131072
    s_waitcnt lgkmcnt(1)
    buffer_store_dwordx4 v[56:59], v20, s[60:63], s8 offen sc1
    s_add_u32 s8, s8, 131072
    s_waitcnt lgkmcnt(0)
    buffer_store_dwordx4 v[60:63], v20, s[60:63], s8 offen sc1
    s_add_u32 s8, s8, 131072
    s_mov_b32 s8, 917504
    ds_read_b128 v[64:67], v14 offset:8192
    ds_read_b128 v[68:71], v14 offset:9216
    ds_read_b128 v[72:75], v14 offset:10240
    ds_read_b128 v[76:79], v14 offset:11264
    ds_read_b128 v[80:83], v14 offset:12288
    ds_read_b128 v[84:87], v14 offset:13312
    ds_read_b128 v[88:91], v14 offset:14336
    ds_read_b128 v[92:95], v14 offset:15360
    s_waitcnt lgkmcnt(7)
    buffer_store_dwordx4 v[64:67], v165, s[60:63], s8 offen sc1
    s_sub_u32 s8, s8, 131072
    s_waitcnt lgkmcnt(6)
    buffer_store_dwordx4 v[68:71], v21, s[60:63], s8 offen sc1
    s_sub_u32 s8, s8, 131072
    s_waitcnt lgkmcnt(5)
    buffer_store_dwordx4 v[72:75], v21, s[60:63], s8 offen sc1
    s_sub_u32 s8, s8, 131072
    s_waitcnt lgkmcnt(4)
    buffer_store_dwordx4 v[76:79], v21, s[60:63], s8 offen sc1
    s_sub_u32 s8, s8, 131072
    s_waitcnt lgkmcnt(3)
    buffer_store_dwordx4 v[80:83], v21, s[60:63], s8 offen sc1
    s_sub_u32 s8, s8, 131072
    s_waitcnt lgkmcnt(2)
    buffer_store_dwordx4 v[84:87], v21, s[60:63], s8 offen sc1
    s_sub_u32 s8, s8, 131072
    s_waitcnt lgkmcnt(1)
    buffer_store_dwordx4 v[88:91], v21, s[60:63], s8 offen sc1
    s_sub_u32 s8, s8, 131072
    s_waitcnt lgkmcnt(0)
    buffer_store_dwordx4 v[92:95], v21, s[60:63], s8 offen sc1
    s_sub_u32 s8, s8, 131072
    s_waitcnt vmcnt(16)
    s_barrier
    s_add_u32 s84, s84, 16384
    s_and_b32 s84, s84, 262143
    s_mov_b32 m0, 16384
    s_mov_b32 s9, s84
    s_mov_b32 s98, 0
L_hl25:
    buffer_load_dwordx4 v1, s[48:51], s9 offen offset:0 sc1 lds
    buffer_load_dwordx4 v1, s[48:51], s9 offen offset:1024 sc1 lds
    buffer_load_dwordx4 v1, s[48:51], s9 offen offset:2048 sc1 lds
    buffer_load_dwordx4 v1, s[48:51], s9 offen offset:3072 sc1 lds
    s_add_u32 m0, m0, 4096
    s_add_u32 s9, s9, 4096
    s_add_u32 s98, s98, 1
    s_cmp_lt_u32 s98, 4
    s_cbranch_scc1 L_hl25
    s_waitcnt vmcnt(16)
    s_add_u32 s8, s78, 1052672
    v_mov_b32 v17, s86
    v_mov_b32 v18, 0
    s_mov_b64 exec, 1
    buffer_store_dword v17, v18, s[60:63], s8 offen sc1
    s_mov_b64 exec, -1
    s_xor_b32 s8, s100, 0
    s_lshl_b32 s8, s8, 17
    s_mov_b32 m0, 98304
    s_mov_b32 s9, s8
    s_mov_b32 s98, 0
L_hl26:
    buffer_load_dwordx4 v24, s[68:71], s9 offen lds
    s_add_u32 s83, s9, 31744
    buffer_load_dwordx4 v24, s[68:71], s83 offen offset:1024 lds
    s_add_u32 m0, m0, 8192
    s_add_u32 s9, s9, 64
    s_add_u32 s98, s98, 1
    s_cmp_lt_u32 s98, 4
    s_cbranch_scc1 L_hl26
    s_add_u32 s8, s8, 65536
    s_mov_b32 m0, 131072
    s_mov_b32 s9, s8
    s_mov_b32 s98, 0
L_hl27:
    buffer_load_dwordx4 v24, s[68:71], s9 offen lds
    s_add_u32 s83, s9, 31744
    buffer_load_dwordx4 v24, s[68:71], s83 offen offset:1024 lds
    s_add_u32 m0, m0, 8192
    s_add_u32 s9, s9, 64
    s_add_u32 s98, s98, 1
    s_cmp_lt_u32 s98, 4
    s_cbranch_scc1 L_hl27
    s_waitcnt vmcnt(17)
    s_barrier
    s_add_u32 s84, s84, 16384
    s_and_b32 s84, s84, 262143
    s_mov_b32 m0, 32768
    s_mov_b32 s9, s84
    s_mov_b32 s98, 0
L_hl28:
    buffer_load_dwordx4 v1, s[48:51], s9 offen offset:0 sc1 lds
    buffer_load_dwordx4 v1, s[48:51], s9 offen offset:1024 sc1 lds
    buffer_load_dwordx4 v1, s[48:51], s9 offen offset:2048 sc1 lds
    buffer_load_dwordx4 v1, s[48:51], s9 offen offset:3072 sc1 lds
    s_add_u32 m0, m0, 4096
    s_add_u32 s9, s9, 4096
    s_add_u32 s98, s98, 1
    s_cmp_lt_u32 s98, 4
    s_cbranch_scc1 L_hl28
    s_xor_b32 s8, s100, 1
    s_lshl_b32 s8, s8, 17
    s_mov_b32 m0, 100352
    s_mov_b32 s9, s8
    s_mov_b32 s98, 0
L_hl29:
    buffer_load_dwordx4 v24, s[68:71], s9 offen lds
    s_add_u32 s83, s9, 31744
    buffer_load_dwordx4 v24, s[68:71], s83 offen offset:1024 lds
    s_add_u32 m0, m0, 8192
    s_add_u32 s9, s9, 64
    s_add_u32 s98, s98, 1
    s_cmp_lt_u32 s98, 4
    s_cbranch_scc1 L_hl29
    s_add_u32 s8, s8, 65536
    s_mov_b32 m0, 133120
    s_mov_b32 s9, s8
    s_mov_b32 s98, 0
L_hl30:
    buffer_load_dwordx4 v24, s[68:71], s9 offen lds
    s_add_u32 s83, s9, 31744
    buffer_load_dwordx4 v24, s[68:71], s83 offen offset:1024 lds
    s_add_u32 m0, m0, 8192
    s_add_u32 s9, s9, 64
    s_add_u32 s98, s98, 1
    s_cmp_lt_u32 s98, 4
    s_cbranch_scc1 L_hl30
    s_waitcnt vmcnt(16)
    s_barrier
    s_add_u32 s84, s84, 16384
    s_and_b32 s84, s84, 262143
    s_mov_b32 m0, 0
    s_mov_b32 s9, s84
    s_mov_b32 s98, 0
L_hl31:
    buffer_load_dwordx4 v1, s[48:51], s9 offen offset:0 sc1 lds
    buffer_load_dwordx4 v1, s[48:51], s9 offen offset:1024 sc1 lds
    buffer_load_dwordx4 v1, s[48:51], s9 offen offset:2048 sc1 lds
    buffer_load_dwordx4 v1, s[48:51], s9 offen offset:3072 sc1 lds
    s_add_u32 m0, m0, 4096
    s_add_u32 s9, s9, 4096
    s_add_u32 s98, s98, 1
    s_cmp_lt_u32 s98, 4
    s_cbranch_scc1 L_hl31
    s_xor_b32 s8, s100, 2
    s_lshl_b32 s8, s8, 17
    s_mov_b32 m0, 102400
    s_mov_b32 s9, s8
    s_mov_b32 s98, 0
L_hl32:
    buffer_load_dwordx4 v24, s[68:71], s9 offen lds
    s_add_u32 s83, s9, 31744
    buffer_load_dwordx4 v24, s[68:71], s83 offen offset:1024 lds
    s_add_u32 m0, m0, 8192
    s_add_u32 s9, s9, 64
    s_add_u32 s98, s98, 1
    s_cmp_lt_u32 s98, 4
    s_cbranch_scc1 L_hl32
    s_add_u32 s8, s8, 65536
    s_mov_b32 m0, 135168
    s_mov_b32 s9, s8
    s_mov_b32 s98, 0
L_hl33:
    buffer_load_dwordx4 v24, s[68:71], s9 offen lds
    s_add_u32 s83, s9, 31744
    buffer_load_dwordx4 v24, s[68:71], s83 offen offset:1024 lds
    s_add_u32 m0, m0, 8192
    s_add_u32 s9, s9, 64
    s_add_u32 s98, s98, 1
    s_cmp_lt_u32 s98, 4
    s_cbranch_scc1 L_hl33
    s_waitcnt vmcnt(16)
    s_barrier
    s_add_u32 s84, s84, 16384
    s_and_b32 s84, s84, 262143
    s_mov_b32 m0, 16384
    s_mov_b32 s9, s84
    s_mov_b32 s98, 0
L_hl34:
    buffer_load_dwordx4 v1, s[48:51], s9 offen offset:0 sc1 lds
    buffer_load_dwordx4 v1, s[48:51], s9 offen offset:1024 sc1 lds
    buffer_load_dwordx4 v1, s[48:51], s9 offen offset:2048 sc1 lds
    buffer_load_dwordx4 v1, s[48:51], s9 offen offset:3072 sc1 lds
    s_add_u32 m0, m0, 4096
    s_add_u32 s9, s9, 4096
    s_add_u32 s98, s98, 1
    s_cmp_lt_u32 s98, 4
    s_cbranch_scc1 L_hl34
    s_xor_b32 s8, s100, 3
    s_lshl_b32 s8, s8, 17
    s_mov_b32 m0, 104448
    s_mov_b32 s9, s8
    s_mov_b32 s98, 0
L_hl35:
    buffer_load_dwordx4 v24, s[68:71], s9 offen lds
    s_add_u32 s83, s9, 31744
    buffer_load_dwordx4 v24, s[68:71], s83 offen offset:1024 lds
    s_add_u32 m0, m0, 8192
    s_add_u32 s9, s9, 64
    s_add_u32 s98, s98, 1
    s_cmp_lt_u32 s98, 4
    s_cbranch_scc1 L_hl35
    s_add_u32 s8, s8, 65536
    s_mov_b32 m0, 137216
    s_mov_b32 s9, s8
    s_mov_b32 s98, 0
L_hl36:
    buffer_load_dwordx4 v24, s[68:71], s9 offen lds
    s_add_u32 s83, s9, 31744
    buffer_load_dwordx4 v24, s[68:71], s83 offen offset:1024 lds
    s_add_u32 m0, m0, 8192
    s_add_u32 s9, s9, 64
    s_add_u32 s98, s98, 1
    s_cmp_lt_u32 s98, 4
    s_cbranch_scc1 L_hl36
    s_waitcnt vmcnt(16)
    s_barrier
    s_add_u32 s84, s84, 16384
    s_and_b32 s84, s84, 262143
    s_mov_b32 m0, 32768
    s_mov_b32 s9, s84
    s_mov_b32 s98, 0
L_hl37:
    buffer_load_dwordx4 v1, s[48:51], s9 offen offset:0 sc1 lds
    buffer_load_dwordx4 v1, s[48:51], s9 offen offset:1024 sc1 lds
    buffer_load_dwordx4 v1, s[48:51], s9 offen offset:2048 sc1 lds
    buffer_load_dwordx4 v1, s[48:51], s9 offen offset:3072 sc1 lds
    s_add_u32 m0, m0, 4096
    s_add_u32 s9, s9, 4096
    s_add_u32 s98, s98, 1
    s_cmp_lt_u32 s98, 4
    s_cbranch_scc1 L_hl37
    s_mov_b32 s99, 1052672
    buffer_load_dwordx4 v[28:31], v13, s[60:63], s99 offen sc1
    s_waitcnt vmcnt(1)
    s_barrier
    s_add_u32 s84, s84, 16384
    s_and_b32 s84, s84, 262143
    s_mov_b32 m0, 0
    s_mov_b32 s9, s84
    s_mov_b32 s98, 0
L_hl38:
    buffer_load_dwordx4 v1, s[48:51], s9 offen offset:0 sc1 lds
    buffer_load_dwordx4 v1, s[48:51], s9 offen offset:1024 sc1 lds
    buffer_load_dwordx4 v1, s[48:51], s9 offen offset:2048 sc1 lds
    buffer_load_dwordx4 v1, s[48:51], s9 offen offset:3072 sc1 lds
    s_add_u32 m0, m0, 4096
    s_add_u32 s9, s9, 4096
    s_add_u32 s98, s98, 1
    s_cmp_lt_u32 s98, 4
    s_cbranch_scc1 L_hl38
    s_mov_b32 s98, 0
    s_branch L_pc39
L_pl39:
    buffer_load_dwordx4 v[28:31], v13, s[60:63], s99 offen sc1
L_pc39:
    s_add_u32 s98, s98, 1
    s_waitcnt vmcnt(0)
    v_xor_b32 v28, s86, v28
    v_xor_b32 v29, s86, v29
    v_xor_b32 v30, s86, v30
    v_xor_b32 v31, s86, v31
    v_or3_b32 v28, v28, v29, v30
    v_or_b32 v28, v28, v31
    v_cmp_lt_u32 vcc, 7, v28
    s_nop 0
    s_cmp_lg_u64 vcc, 0
    s_cbranch_scc0 L_po39
    s_cmp_lt_u32 s98, 0x8000
    s_cbranch_scc1 L_pl39
L_po39:
    s_cmp_eq_u32 s11, 128
    s_cselect_b32 s74, 128, s39
    s_lshl_b32 s74, s74, 14
    s_add_u32 s74, s74, 10485760
    s_lshl_b32 s75, s39, 14
    s_add_u32 s75, s75, 12582912
    v_xor_b32 v14, 0, v1
    s_mov_b32 m0, 49152
    s_add_u32 s8, s74, 0
    buffer_load_dwordx4 v14, s[60:63], s8 offen sc1 lds
    buffer_load_dwordx4 v14, s[60:63], s8 offen offset:1024 sc1 lds
    s_mov_b32 m0, 81920
    s_add_u32 s8, s75, 0
    buffer_load_dwordx4 v14, s[60:63], s8 offen sc1 lds
    buffer_load_dwordx4 v14, s[60:63], s8 offen offset:1024 sc1 lds
    v_xor_b32 v14, 64, v1
    s_mov_b32 m0, 51200
    s_add_u32 s8, s74, 2048
    buffer_load_dwordx4 v14, s[60:63], s8 offen sc1 lds
    buffer_load_dwordx4 v14, s[60:63], s8 offen offset:1024 sc1 lds
    s_mov_b32 m0, 83968
    s_add_u32 s8, s75, 2048
    buffer_load_dwordx4 v14, s[60:63], s8 offen sc1 lds
    buffer_load_dwordx4 v14, s[60:63], s8 offen offset:1024 sc1 lds
    v_xor_b32 v14, 128, v1
    s_mov_b32 m0, 53248
    s_add_u32 s8, s74, 4096
    buffer_load_dwordx4 v14, s[60:63], s8 offen sc1 lds
    buffer_load_dwordx4 v14, s[60:63], s8 offen offset:1024 sc1 lds
    s_mov_b32 m0, 86016
    s_add_u32 s8, s75, 4096
    buffer_load_dwordx4 v14, s[60:63], s8 offen sc1 lds
    buffer_load_dwordx4 v14, s[60:63], s8 offen offset:1024 sc1 lds
    v_xor_b32 v14, 192, v1
    s_mov_b32 m0, 55296
    s_add_u32 s8, s74, 6144
    buffer_load_dwordx4 v14, s[60:63], s8 offen sc1 lds
    buffer_load_dwordx4 v14, s[60:63], s8 offen offset:1024 sc1 lds
    s_mov_b32 m0, 88064
    s_add_u32 s8, s75, 6144
    buffer_load_dwordx4 v14, s[60:63], s8 offen sc1 lds
    buffer_load_dwordx4 v14, s[60:63], s8 offen offset:1024 sc1 lds
    v_xor_b32 v14, 0, v1
    s_mov_b32 m0, 57344
    s_add_u32 s8, s74, 8192
    buffer_load_dwordx4 v14, s[60:63], s8 offen sc1 lds
    buffer_load_dwordx4 v14, s[60:63], s8 offen offset:1024 sc1 lds
    s_mov_b32 m0, 90112
    s_add_u32 s8, s75, 8192
    buffer_load_dwordx4 v14, s[60:63], s8 offen sc1 lds
    buffer_load_dwordx4 v14, s[60:63], s8 offen offset:1024 sc1 lds
    v_xor_b32 v14, 64, v1
    s_mov_b32 m0, 59392
    s_add_u32 s8, s74, 10240
    buffer_load_dwordx4 v14, s[60:63], s8 offen sc1 lds
    buffer_load_dwordx4 v14, s[60:63], s8 offen offset:1024 sc1 lds
    s_mov_b32 m0, 92160
    s_add_u32 s8, s75, 10240
    buffer_load_dwordx4 v14, s[60:63], s8 offen sc1 lds
    buffer_load_dwordx4 v14, s[60:63], s8 offen offset:1024 sc1 lds
    v_xor_b32 v14, 128, v1
    s_mov_b32 m0, 61440
    s_add_u32 s8, s74, 12288
    buffer_load_dwordx4 v14, s[60:63], s8 offen sc1 lds
    buffer_load_dwordx4 v14, s[60:63], s8 offen offset:1024 sc1 lds
    s_mov_b32 m0, 94208
    s_add_u32 s8, s75, 12288
    buffer_load_dwordx4 v14, s[60:63], s8 offen sc1 lds
    buffer_load_dwordx4 v14, s[60:63], s8 offen offset:1024 sc1 lds
    v_xor_b32 v14, 192, v1
    s_mov_b32 m0, 63488
    s_add_u32 s8, s74, 14336
    buffer_load_dwordx4 v14, s[60:63], s8 offen sc1 lds
    buffer_load_dwordx4 v14, s[60:63], s8 offen offset:1024 sc1 lds
    s_mov_b32 m0, 96256
    s_add_u32 s8, s75, 14336
    buffer_load_dwordx4 v14, s[60:63], s8 offen sc1 lds
    buffer_load_dwordx4 v14, s[60:63], s8 offen offset:1024 sc1 lds
    s_barrier
    s_waitcnt vmcnt(0)
    s_barrier
    v_and_b32 v15, 1, v0
    v_lshlrev_b32 v15, 4, v15
    s_lshl_b32 s99, s4, 7
    s_add_u32 s99, s99, 1056768
    s_lshl_b32 s8, s4, 17
    s_add_u32 s8, s8, 6291456
    s_add_u32 s48, s36, s8
    s_addc_u32 s49, s37, 0
    s_mov_b32 s50, 131072
    s_barrier
    s_cmp_eq_u32 s85, 0
    s_cbranch_scc1 L_hslow
    s_add_u32 s8, s78, 1056768
    v_mov_b32 v17, s86
    v_mov_b32 v18, 0
    s_mov_b64 exec, 1
    buffer_store_dword v17, v18, s[60:63], s8 offen
    s_mov_b64 exec, -1
    s_branch L_hj
L_hslow:
    s_add_u32 s8, s78, 1056768
    v_mov_b32 v17, s86
    v_mov_b32 v18, 0
    s_mov_b64 exec, 1
    buffer_store_dword v17, v18, s[60:63], s8 offen sc1
    s_mov_b64 exec, -1
L_hj:
    s_mov_b32 s98, 0
L_pl40:
    buffer_load_dwordx4 v[28:31], v15, s[60:63], s99 offen sc1
L_pc40:
    s_add_u32 s98, s98, 1
    s_waitcnt vmcnt(0)
    v_xor_b32 v28, s86, v28
    v_xor_b32 v29, s86, v29
    v_xor_b32 v30, s86, v30
    v_xor_b32 v31, s86, v31
    v_or3_b32 v28, v28, v29, v30
    v_or_b32 v28, v28, v31
    v_cmp_lt_u32 vcc, 7, v28
    s_nop 0
    s_cmp_lg_u64 vcc, 0
    s_cbranch_scc0 L_po40
    s_cmp_lt_u32 s98, 0x8000
    s_cbranch_scc1 L_pl40
L_po40:
    s_barrier
    s_barrier
    s_xor_b32 s9, s100, 8
    s_mov_b32 m0, 0
    s_lshl_b32 s9, s9, 13
    buffer_load_dwordx4 v1, s[48:51], s9 offen offset:0 sc1 lds
    buffer_load_dwordx4 v1, s[48:51], s9 offen offset:1024 sc1 lds
    buffer_load_dwordx4 v1, s[48:51], s9 offen offset:2048 sc1 lds
    buffer_load_dwordx4 v1, s[48:51], s9 offen offset:3072 sc1 lds
    s_add_u32 m0, m0, 4096
    s_add_u32 s9, s9, 4096
    buffer_load_dwordx4 v1, s[48:51], s9 offen offset:0 sc1 lds
    buffer_load_dwordx4 v1, s[48:51], s9 offen offset:1024 sc1 lds
    buffer_load_dwordx4 v1, s[48:51], s9 offen offset:2048 sc1 lds
    buffer_load_dwordx4 v1, s[48:51], s9 offen offset:3072 sc1 lds
    s_xor_b32 s9, s100, 9
    s_mov_b32 m0, 8192
    s_lshl_b32 s9, s9, 13
    buffer_load_dwordx4 v1, s[48:51], s9 offen offset:0 sc1 lds
    buffer_load_dwordx4 v1, s[48:51], s9 offen offset:1024 sc1 lds
    buffer_load_dwordx4 v1, s[48:51], s9 offen offset:2048 sc1 lds
    buffer_load_dwordx4 v1, s[48:51], s9 offen offset:3072 sc1 lds
    s_add_u32 m0, m0, 4096
    s_add_u32 s9, s9, 4096
    buffer_load_dwordx4 v1, s[48:51], s9 offen offset:0 sc1 lds
    buffer_load_dwordx4 v1, s[48:51], s9 offen offset:1024 sc1 lds
    buffer_load_dwordx4 v1, s[48:51], s9 offen offset:2048 sc1 lds
    buffer_load_dwordx4 v1, s[48:51], s9 offen offset:3072 sc1 lds
    s_waitcnt vmcnt(0)
    s_barrier
    s_xor_b32 s9, s100, 10
    s_mov_b32 m0, 16384
    s_lshl_b32 s9, s9, 13
    buffer_load_dwordx4 v1, s[48:51], s9 offen offset:0 sc1 lds
    buffer_load_dwordx4 v1, s[48:51], s9 offen offset:1024 sc1 lds
    buffer_load_dwordx4 v1, s[48:51], s9 offen offset:2048 sc1 lds
    buffer_load_dwordx4 v1, s[48:51], s9 offen offset:3072 sc1 lds
    s_add_u32 m0, m0, 4096
    s_add_u32 s9, s9, 4096
    buffer_load_dwordx4 v1, s[48:51], s9 offen offset:0 sc1 lds
    buffer_load_dwordx4 v1, s[48:51], s9 offen offset:1024 sc1 lds
    buffer_load_dwordx4 v1, s[48:51], s9 offen offset:2048 sc1 lds
    buffer_load_dwordx4 v1, s[48:51], s9 offen offset:3072 sc1 lds
    s_xor_b32 s9, s100, 11
    s_mov_b32 m0, 24576
    s_lshl_b32 s9, s9, 13
    buffer_load_dwordx4 v1, s[48:51], s9 offen offset:0 sc1 lds
    buffer_load_dwordx4 v1, s[48:51], s9 offen offset:1024 sc1 lds
    buffer_load_dwordx4 v1, s[48:51], s9 offen offset:2048 sc1 lds
    buffer_load_dwordx4 v1, s[48:51], s9 offen offset:3072 sc1 lds
    s_add_u32 m0, m0, 4096
    s_add_u32 s9, s9, 4096
    buffer_load_dwordx4 v1, s[48:51], s9 offen offset:0 sc1 lds
    buffer_load_dwordx4 v1, s[48:51], s9 offen offset:1024 sc1 lds
    buffer_load_dwordx4 v1, s[48:51], s9 offen offset:2048 sc1 lds
    buffer_load_dwordx4 v1, s[48:51], s9 offen offset:3072 sc1 lds
    s_waitcnt vmcnt(0)
    s_barrier
    s_xor_b32 s9, s100, 14
    s_mov_b32 m0, 65536
    s_lshl_b32 s9, s9, 13
    buffer_load_dwordx4 v1, s[48:51], s9 offen offset:0 sc1 lds
    buffer_load_dwordx4 v1, s[48:51], s9 offen offset:1024 sc1 lds
    buffer_load_dwordx4 v1, s[48:51], s9 offen offset:2048 sc1 lds
    buffer_load_dwordx4 v1, s[48:51], s9 offen offset:3072 sc1 lds
    s_add_u32 m0, m0, 4096
    s_add_u32 s9, s9, 4096
    buffer_load_dwordx4 v1, s[48:51], s9 offen offset:0 sc1 lds
    buffer_load_dwordx4 v1, s[48:51], s9 offen offset:1024 sc1 lds
    buffer_load_dwordx4 v1, s[48:51], s9 offen offset:2048 sc1 lds
    buffer_load_dwordx4 v1, s[48:51], s9 offen offset:3072 sc1 lds
    s_xor_b32 s9, s100, 15
    s_mov_b32 m0, 73728
    s_lshl_b32 s9, s9, 13
    buffer_load_dwordx4 v1, s[48:51], s9 offen offset:0 sc1 lds
    buffer_load_dwordx4 v1, s[48:51], s9 offen offset:1024 sc1 lds
    buffer_load_dwordx4 v1, s[48:51], s9 offen offset:2048 sc1 lds
    buffer_load_dwordx4 v1, s[48:51], s9 offen offset:3072 sc1 lds
    s_add_u32 m0, m0, 4096
    s_add_u32 s9, s9, 4096
    buffer_load_dwordx4 v1, s[48:51], s9 offen offset:0 sc1 lds
    buffer_load_dwordx4 v1, s[48:51], s9 offen offset:1024 sc1 lds
    buffer_load_dwordx4 v1, s[48:51], s9 offen offset:2048 sc1 lds
    buffer_load_dwordx4 v1, s[48:51], s9 offen offset:3072 sc1 lds
    s_waitcnt vmcnt(0)
    s_barrier
L_last:
    s_endpgm
.section .rodata,"a"
.p2align 6
.amdhsa_kernel concat_heads__spectral_fnet__grouped_kv_mqa__prompt_kernel
  .amdhsa_next_free_vgpr 168
  .amdhsa_next_free_sgpr 102
  .amdhsa_accum_offset 168
  .amdhsa_group_segment_fixed_size 0
  .amdhsa_kernarg_size 104
  .amdhsa_user_sgpr_count 2
  .amdhsa_user_sgpr_kernarg_segment_ptr 1
  .amdhsa_system_sgpr_workgroup_id_x 1
.end_amdhsa_kernel
```
